```python
import torch

def _softmax(x, axis=-1):
    return torch.softmax(x, dim=axis)
def _gelu(x):
    return torch.nn.functional.gelu(x, approximate="tanh")
def _silu(x):
    return torch.nn.functional.silu(x)
def _sigmoid(x):
    return torch.sigmoid(x)
def _layernorm(x, axis=-1, eps=1e-5):
    m = x.mean(dim=axis, keepdim=True)
    v = x.var(dim=axis, keepdim=True, unbiased=False)
    return (x - m) / torch.sqrt(v + eps)
def _scatter_add(tgt, idx, src, axis=0):
    return tgt.clone().index_add_(axis, idx, src)
def _segment_sum(src, seg, n):
    out = torch.zeros((n,) + src.shape[1:], dtype=src.dtype)
    return out.index_add_(0, seg, src)
def _pad(x, pw):
    flat = tuple(v for pair in reversed(pw) for v in pair)
    return torch.nn.functional.pad(x, flat)

kernel_name = 'sequential_preLN__gqa_block_cached__swiglu_ffn__decode'

def setup_inputs():

    _w = (lambda a: (lambda t: t.to(torch.bfloat16) if t.is_floating_point() else t)(torch.as_tensor(a)))
    def _A_setup():
        B, Sq, D = 2, 1, 512
        Hq, Hkv, Sk, Dh = 32, 8, 32768, 128
        assert Hq % Hkv == 0, (Hq, Hkv)
        return {
            "x": _w((lambda *s: torch.randn(*s, dtype=torch.bfloat16) * 0.05)(B, Sq, D)),
            "k_cache": _w((lambda *s: torch.randn(*s, dtype=torch.bfloat16) * 3.2)(B, Hkv, Sk, Dh)),
            "v_cache": _w((lambda *s: torch.randn(*s, dtype=torch.bfloat16) * 0.4)(B, Hkv, Sk, Dh)),
            "wq": _w((lambda *s: torch.randn(*s, dtype=torch.bfloat16) * 3.2)(D, Hq * Dh) * (D ** -0.5)),
            "wo": _w((lambda *s: torch.randn(*s, dtype=torch.bfloat16) * 0.4)(Hq * Dh, D) * ((Hq * Dh) ** -0.5)),
        }
    _A_in = _A_setup()

    def _B_setup():
        B, S, D, F = 2, 1, 512, 1792
        return {
            "x": _w((lambda *s: torch.randn(*s, dtype=torch.bfloat16) * 0.05)(B, S, D)),
            "w_gate": _w((lambda *s: torch.randn(*s, dtype=torch.bfloat16) * 0.05)(D, F)),
            "w_up": _w((lambda *s: torch.randn(*s, dtype=torch.bfloat16) * 0.05)(D, F)),
            "w_down": _w((lambda *s: torch.randn(*s, dtype=torch.bfloat16) * 0.05)(F, D)),
        }
    _B_in = _B_setup()

    return {
        "A_x": _A_in["x"],
        "A_k_cache": _A_in["k_cache"],
        "A_v_cache": _A_in["v_cache"],
        "A_wq": _A_in["wq"],
        "A_wo": _A_in["wo"],
        "B_x": _B_in["x"],
        "B_w_gate": _B_in["w_gate"],
        "B_w_up": _B_in["w_up"],
        "B_w_down": _B_in["w_down"],
    }

def reference(A_x, A_k_cache, A_v_cache, A_wq, A_wo, B_x, B_w_gate, B_w_up, B_w_down):
    def _A_ref(x, k_cache, v_cache, wq, wo):
        B, Sq, D = x.shape
        Hq, Dh = 32, 128
        Hkv = k_cache.shape[1]
        rep = Hq // Hkv
        q = (lambda x, *d: x.permute(*d))((x @ wq).reshape(B, Sq, Hq, Dh), 0, 2, 1, 3)
        k = (lambda x, n, axis: torch.repeat_interleave(x, n, dim=axis))(k_cache, rep, axis=1)
        v = (lambda x, n, axis: torch.repeat_interleave(x, n, dim=axis))(v_cache, rep, axis=1)
        scores = torch.einsum("bhqd,bhkd->bhqk", q, k) * (Dh ** -0.5)
        p = _softmax(scores, axis=-1)
        o = torch.einsum("bhqk,bhkd->bhqd", p, v)
        return (lambda x, *d: x.permute(*d))(o, 0, 2, 1, 3).reshape(B, Sq, Hq * Dh) @ wo

    def _B_ref(x, w_gate, w_up, w_down):
        g = _silu(x @ w_gate)
        u = x @ w_up
        return (g * u) @ w_down

    x = A_x
    h = x + _A_ref(_layernorm(x, axis=-1), A_k_cache, A_v_cache, A_wq, A_wo)
    h2 = h + _B_ref(_layernorm(h, axis=-1), B_w_gate, B_w_up, B_w_down)
    return h2
```

```asm
; @launch grid=(256,1,1) block=(512,1,1) lds=18720
.amdgcn_target "amdgcn-amd-amdhsa--gfx950"
.text
.globl sequential_preLN__gqa_block_cached__swiglu_ffn__decode_kernel
.p2align 8
.type sequential_preLN__gqa_block_cached__swiglu_ffn__decode_kernel,@function
sequential_preLN__gqa_block_cached__swiglu_ffn__decode_kernel:
    s_cmp_ge_u32 s2, 256
    s_cbranch_scc1 L_exit
    s_load_dwordx16 s[16:31], s[0:1], 0
    s_load_dwordx8 s[32:39], s[0:1], 64
    s_and_b32 s3, s2, 15
    s_lshl_b32 s3, s3, 4
    s_lshr_b32 s2, s2, 4
    s_or_b32 s2, s2, s3
    v_and_b32 v1, 63, v0
    v_lshrrev_b32 v2, 4, v1
    v_and_b32 v3, 15, v0
    v_lshrrev_b32 v4, 6, v0
    s_mov_b32 s6, 0xff00ff00
    s_mov_b32 s7, 0xff00ff00
    v_readfirstlane_b32 s3, v4
    s_and_b32 s8, s2, 7
    s_bfe_u32 s9, s2, 0x10003
    s_lshr_b32 s10, s2, 4
    s_lshr_b32 s11, s2, 3
    s_mov_b32 s4, 0x3fb8aa3b
    s_mov_b32 s5, 0x3db504f3
    s_mov_b32 s74, 0
    s_mov_b32 s75, 0x200000
    s_mov_b32 s73, 0
    s_cmp_lt_u32 s2, 120
    s_cselect_b32 s73, 3, s73
    s_cmp_lt_u32 s2, 64
    s_cselect_b32 s73, 2, s73
    s_cmp_lt_u32 s2, 32
    s_cselect_b32 s73, 1, s73
    s_and_b32 s76, s11, 3
    s_mov_b32 s79, 0x7c000
    s_cmp_eq_u32 s73, 2
    s_cmov_b32 s79, 0x7c000
    s_cmp_eq_u32 s73, 3
    s_cmov_b32 s79, 0x7c000
    s_lshl_b32 s80, s10, 19
    s_lshl_b32 s13, s9, 3
    s_add_u32 s13, s13, s8
    s_lshl_b32 s78, s13, 23
    v_and_b32 v5, 3, v3
    v_lshlrev_b32 v5, 10, v5
    v_lshrrev_b32 v6, 2, v3
    v_lshl_add_u32 v5, v6, 8, v5
    v_lshl_add_u32 v5, v2, 4, v5
    v_lshlrev_b32 v6, 8, v2
    v_lshl_add_u32 v6, v3, 4, v6
    s_cmp_ge_u32 s3, 4
    s_cbranch_scc1 L_noprio
    s_setprio 3
L_noprio:
    s_mov_b32 s77, s3
    v_mov_b32 v70, 17664
    v_mov_b32 v71, 0x1000
    v_mov_b32 v8, 0
    v_mov_b32 v9, 0
    v_mov_b32 v10, 0
    v_mov_b32 v11, 0
    ds_write_b128 v70, v[8:11]
    ds_write_b32 v70, v10 offset:1040
    v_mov_b32 v12, 0xfffffffe
    v_mov_b32 v13, 0xfffffffe
    v_mov_b32 v14, 0xfffffffe
    v_mov_b32 v15, 0xfffffffe
    v_lshlrev_b32 v4, 4, v1
    ds_write_b128 v4, v[12:15] offset:17680
    s_waitcnt lgkmcnt(0)
    s_load_dword s72, s[38:39], 0
    s_mov_b32 s64, s16
    s_and_b32 s65, s17, 0xffff
    s_mov_b32 s66, 0x800
    s_mov_b32 s67, 0x00020000
    s_add_u32 s40, s18, s78
    s_addc_u32 s41, s19, 0
    s_and_b32 s41, s41, 0xffff
    s_mov_b32 s42, 0x800000
    s_mov_b32 s43, 0x00020000
    s_add_u32 s44, s20, s78
    s_addc_u32 s45, s21, 0
    s_and_b32 s45, s45, 0xffff
    s_mov_b32 s46, 0x800000
    s_mov_b32 s47, 0x00020000
    s_mov_b32 s52, s38
    s_and_b32 s53, s39, 0xffff
    s_mov_b32 s54, 0x180000
    s_mov_b32 s55, 0x00020000
    s_mov_b32 s20, s80
    s_mov_b32 s21, s79
    s_cmp_lt_u32 s2, 128
    s_cbranch_scc1 L_noprod
    s_cmp_ge_u32 s3, 2
    s_cbranch_scc1 L_noprod
    s_mov_b32 s48, s22
    s_and_b32 s49, s23, 0xffff
    s_mov_b32 s50, 0x400000
    s_mov_b32 s51, 0x00020000
    v_lshlrev_b32 v4, 5, v1
    buffer_load_dwordx4 v[8:11], v4, s[64:67], 0 offen
    buffer_load_dwordx4 v[12:15], v4, s[64:67], 0 offen offset:16
    v_lshrrev_b32 v4, 3, v3
    v_lshlrev_b32 v4, 10, v4
    v_lshl_add_u32 v4, v2, 5, v4
    s_and_b32 s11, s2, 31
    s_bfe_u32 s13, s2, 0x20005
    s_lshl_b32 s13, s13, 1
    s_add_u32 s80, s13, s3
    s_lshl_b32 s12, s80, 7
    buffer_load_dwordx4 v[16:19], v4, s[64:67], s12 offen
    buffer_load_dwordx4 v[20:23], v4, s[64:67], s12 offen offset:16
    s_lshl_b32 s13, s80, 19
    s_lshl_b32 s12, s11, 8
    s_add_u32 s13, s13, s12
    v_lshlrev_b32 v4, 17, v2
    v_lshl_add_u32 v4, v3, 4, v4
    buffer_load_dwordx4 v[72:75], v4, s[48:51], s13 offen nt
    s_add_u32 s13, s13, 8192
    buffer_load_dwordx4 v[76:79], v4, s[48:51], s13 offen nt
    s_add_u32 s13, s13, 8192
    buffer_load_dwordx4 v[80:83], v4, s[48:51], s13 offen nt
    s_add_u32 s13, s13, 8192
    buffer_load_dwordx4 v[84:87], v4, s[48:51], s13 offen nt
    s_add_u32 s13, s13, 8192
    buffer_load_dwordx4 v[88:91], v4, s[48:51], s13 offen nt
    s_add_u32 s13, s13, 8192
    buffer_load_dwordx4 v[92:95], v4, s[48:51], s13 offen nt
    s_add_u32 s13, s13, 8192
    buffer_load_dwordx4 v[96:99], v4, s[48:51], s13 offen nt
    s_add_u32 s13, s13, 8192
    buffer_load_dwordx4 v[100:103], v4, s[48:51], s13 offen nt
    s_add_u32 s13, s13, 8192
    buffer_load_dwordx4 v[104:107], v4, s[48:51], s13 offen nt
    s_add_u32 s13, s13, 8192
    buffer_load_dwordx4 v[108:111], v4, s[48:51], s13 offen nt
    s_add_u32 s13, s13, 8192
    buffer_load_dwordx4 v[112:115], v4, s[48:51], s13 offen nt
    s_add_u32 s13, s13, 8192
    buffer_load_dwordx4 v[116:119], v4, s[48:51], s13 offen nt
    s_add_u32 s13, s13, 8192
    buffer_load_dwordx4 v[120:123], v4, s[48:51], s13 offen nt
    s_add_u32 s13, s13, 8192
    buffer_load_dwordx4 v[124:127], v4, s[48:51], s13 offen nt
    s_add_u32 s13, s13, 8192
    buffer_load_dwordx4 v[128:131], v4, s[48:51], s13 offen nt
    s_add_u32 s13, s13, 8192
    buffer_load_dwordx4 v[132:135], v4, s[48:51], s13 offen nt
    s_add_u32 s13, s13, 8192
    s_barrier
    v_and_b32 v48, 1, v3
    v_cmp_eq_u32 vcc, 1, v48
    v_mov_b32 v48, 0xc0c0100
    v_mov_b32 v49, 0x1000c0c
    v_cndmask_b32 v49, v48, v49, vcc
    v_bfe_u32 v48, v3, 1, 2
    v_cmp_eq_u32 vcc, 0, v48
    v_mov_b32 v232, 0x0c0c0c0c
    s_nop 0
    v_cndmask_b32 v232, v232, v49, vcc
    v_cmp_eq_u32 vcc, 1, v48
    v_mov_b32 v233, 0x0c0c0c0c
    s_nop 0
    v_cndmask_b32 v233, v233, v49, vcc
    v_cmp_eq_u32 vcc, 2, v48
    v_mov_b32 v234, 0x0c0c0c0c
    s_nop 0
    v_cndmask_b32 v234, v234, v49, vcc
    v_cmp_eq_u32 vcc, 3, v48
    v_mov_b32 v235, 0x0c0c0c0c
    s_nop 0
    v_cndmask_b32 v235, v235, v49, vcc
    v_and_b32 v48, 1, v3
    v_cmp_eq_u32 vcc, 1, v48
    v_mov_b32 v48, 0xc0c0302
    v_mov_b32 v49, 0x3020c0c
    v_cndmask_b32 v49, v48, v49, vcc
    v_bfe_u32 v48, v3, 1, 2
    v_cmp_eq_u32 vcc, 0, v48
    v_mov_b32 v236, 0x0c0c0c0c
    s_nop 0
    v_cndmask_b32 v236, v236, v49, vcc
    v_cmp_eq_u32 vcc, 1, v48
    v_mov_b32 v237, 0x0c0c0c0c
    s_nop 0
    v_cndmask_b32 v237, v237, v49, vcc
    v_cmp_eq_u32 vcc, 2, v48
    v_mov_b32 v238, 0x0c0c0c0c
    s_nop 0
    v_cndmask_b32 v238, v238, v49, vcc
    v_cmp_eq_u32 vcc, 3, v48
    v_mov_b32 v239, 0x0c0c0c0c
    s_nop 0
    v_cndmask_b32 v239, v239, v49, vcc
    v_lshlrev_b32 v4, 4, v1
    s_lshl_b32 s13, s11, 14
    s_lshl_b32 s12, s80, 11
    s_add_u32 s13, s13, s12
    s_add_u32 s13, s13, 0x100000
    s_waitcnt vmcnt(16)
    v_lshlrev_b32 v32, 16, v8
    v_and_b32 v33, 0xffff0000, v8
    v_lshlrev_b32 v34, 16, v9
    v_and_b32 v35, 0xffff0000, v9
    v_lshlrev_b32 v36, 16, v10
    v_and_b32 v37, 0xffff0000, v10
    v_lshlrev_b32 v38, 16, v11
    v_and_b32 v39, 0xffff0000, v11
    v_lshlrev_b32 v40, 16, v12
    v_and_b32 v41, 0xffff0000, v12
    v_lshlrev_b32 v42, 16, v13
    v_and_b32 v43, 0xffff0000, v13
    v_lshlrev_b32 v44, 16, v14
    v_and_b32 v45, 0xffff0000, v14
    v_lshlrev_b32 v46, 16, v15
    v_and_b32 v47, 0xffff0000, v15
    v_add_f32 v48, v32, v33
    v_add_f32 v49, v34, v35
    v_add_f32 v48, v48, v36
    v_add_f32 v49, v49, v37
    v_add_f32 v48, v48, v38
    v_add_f32 v49, v49, v39
    v_add_f32 v48, v48, v40
    v_add_f32 v49, v49, v41
    v_add_f32 v48, v48, v42
    v_add_f32 v49, v49, v43
    v_add_f32 v48, v48, v44
    v_add_f32 v49, v49, v45
    v_add_f32 v48, v48, v46
    v_add_f32 v49, v49, v47
    v_add_f32 v50, v48, v49
    s_nop 1
    v_add_f32_dpp v50, v50, v50 quad_perm:[1,0,3,2] row_mask:0xf bank_mask:0xf
    s_nop 1
    v_add_f32_dpp v50, v50, v50 quad_perm:[2,3,0,1] row_mask:0xf bank_mask:0xf
    s_nop 1
    v_add_f32_dpp v50, v50, v50 row_half_mirror row_mask:0xf bank_mask:0xf
    s_nop 1
    v_add_f32_dpp v50, v50, v50 row_mirror row_mask:0xf bank_mask:0xf
    v_mov_b32 v48, v50
    s_nop 1
    v_permlane16_swap_b32 v50, v48
    v_add_f32 v50, v50, v48
    v_mul_f32 v50, 0x3b000000, v50
    v_sub_f32 v32, v32, v50
    v_sub_f32 v33, v33, v50
    v_sub_f32 v34, v34, v50
    v_sub_f32 v35, v35, v50
    v_sub_f32 v36, v36, v50
    v_sub_f32 v37, v37, v50
    v_sub_f32 v38, v38, v50
    v_sub_f32 v39, v39, v50
    v_sub_f32 v40, v40, v50
    v_sub_f32 v41, v41, v50
    v_sub_f32 v42, v42, v50
    v_sub_f32 v43, v43, v50
    v_sub_f32 v44, v44, v50
    v_sub_f32 v45, v45, v50
    v_sub_f32 v46, v46, v50
    v_sub_f32 v47, v47, v50
    v_mul_f32 v48, v32, v32
    v_mul_f32 v49, v33, v33
    v_fmac_f32 v48, v34, v34
    v_fmac_f32 v49, v35, v35
    v_fmac_f32 v48, v36, v36
    v_fmac_f32 v49, v37, v37
    v_fmac_f32 v48, v38, v38
    v_fmac_f32 v49, v39, v39
    v_fmac_f32 v48, v40, v40
    v_fmac_f32 v49, v41, v41
    v_fmac_f32 v48, v42, v42
    v_fmac_f32 v49, v43, v43
    v_fmac_f32 v48, v44, v44
    v_fmac_f32 v49, v45, v45
    v_fmac_f32 v48, v46, v46
    v_fmac_f32 v49, v47, v47
    v_add_f32 v51, v48, v49
    s_nop 1
    v_add_f32_dpp v51, v51, v51 quad_perm:[1,0,3,2] row_mask:0xf bank_mask:0xf
    s_nop 1
    v_add_f32_dpp v51, v51, v51 quad_perm:[2,3,0,1] row_mask:0xf bank_mask:0xf
    s_nop 1
    v_add_f32_dpp v51, v51, v51 row_half_mirror row_mask:0xf bank_mask:0xf
    s_nop 1
    v_add_f32_dpp v51, v51, v51 row_mirror row_mask:0xf bank_mask:0xf
    v_mov_b32 v48, v51
    s_nop 1
    v_permlane16_swap_b32 v51, v48
    v_add_f32 v51, v51, v48
    v_mul_f32 v51, 0x3b000000, v51
    v_cvt_pk_bf16_f32 v50, 0, v50
    v_cvt_pk_bf16_f32 v51, 0, v51
    v_add_f32 v51, 0x3727c5ac, v51
    v_cvt_pk_bf16_f32 v51, 0, v51
    v_sqrt_f32 v51, v51
    s_nop 0
    v_cvt_pk_bf16_f32 v51, 0, v51
    v_rcp_f32 v51, v51
    v_mov_b32 v48, v50
    v_mov_b32 v49, v51
    s_nop 1
    v_permlane32_swap_b32 v50, v48
    v_permlane32_swap_b32 v51, v49
    s_nop 1
    v_cndmask_b32 v50, v50, v48, s[6:7]
    v_cndmask_b32 v51, v51, v49, s[6:7]
    v_lshlrev_b32 v48, 16, v16
    v_and_b32 v49, 0xffff0000, v16
    v_sub_f32 v48, v48, v50
    v_sub_f32 v49, v49, v50
    v_cvt_pk_bf16_f32 v48, 0, v48
    v_cvt_pk_bf16_f32 v49, 0, v49
    v_mul_f32 v48, v48, v51
    v_mul_f32 v49, v49, v51
    v_cvt_pk_bf16_f32 v16, v48, v49
    v_lshlrev_b32 v48, 16, v17
    v_and_b32 v49, 0xffff0000, v17
    v_sub_f32 v48, v48, v50
    v_sub_f32 v49, v49, v50
    v_cvt_pk_bf16_f32 v48, 0, v48
    v_cvt_pk_bf16_f32 v49, 0, v49
    v_mul_f32 v48, v48, v51
    v_mul_f32 v49, v49, v51
    v_cvt_pk_bf16_f32 v17, v48, v49
    v_lshlrev_b32 v48, 16, v18
    v_and_b32 v49, 0xffff0000, v18
    v_sub_f32 v48, v48, v50
    v_sub_f32 v49, v49, v50
    v_cvt_pk_bf16_f32 v48, 0, v48
    v_cvt_pk_bf16_f32 v49, 0, v49
    v_mul_f32 v48, v48, v51
    v_mul_f32 v49, v49, v51
    v_cvt_pk_bf16_f32 v18, v48, v49
    v_lshlrev_b32 v48, 16, v19
    v_and_b32 v49, 0xffff0000, v19
    v_sub_f32 v48, v48, v50
    v_sub_f32 v49, v49, v50
    v_cvt_pk_bf16_f32 v48, 0, v48
    v_cvt_pk_bf16_f32 v49, 0, v49
    v_mul_f32 v48, v48, v51
    v_mul_f32 v49, v49, v51
    v_cvt_pk_bf16_f32 v19, v48, v49
    v_lshlrev_b32 v48, 16, v20
    v_and_b32 v49, 0xffff0000, v20
    v_sub_f32 v48, v48, v50
    v_sub_f32 v49, v49, v50
    v_cvt_pk_bf16_f32 v48, 0, v48
    v_cvt_pk_bf16_f32 v49, 0, v49
    v_mul_f32 v48, v48, v51
    v_mul_f32 v49, v49, v51
    v_cvt_pk_bf16_f32 v20, v48, v49
    v_lshlrev_b32 v48, 16, v21
    v_and_b32 v49, 0xffff0000, v21
    v_sub_f32 v48, v48, v50
    v_sub_f32 v49, v49, v50
    v_cvt_pk_bf16_f32 v48, 0, v48
    v_cvt_pk_bf16_f32 v49, 0, v49
    v_mul_f32 v48, v48, v51
    v_mul_f32 v49, v49, v51
    v_cvt_pk_bf16_f32 v21, v48, v49
    v_lshlrev_b32 v48, 16, v22
    v_and_b32 v49, 0xffff0000, v22
    v_sub_f32 v48, v48, v50
    v_sub_f32 v49, v49, v50
    v_cvt_pk_bf16_f32 v48, 0, v48
    v_cvt_pk_bf16_f32 v49, 0, v49
    v_mul_f32 v48, v48, v51
    v_mul_f32 v49, v49, v51
    v_cvt_pk_bf16_f32 v22, v48, v49
    v_lshlrev_b32 v48, 16, v23
    v_and_b32 v49, 0xffff0000, v23
    v_sub_f32 v48, v48, v50
    v_sub_f32 v49, v49, v50
    v_cvt_pk_bf16_f32 v48, 0, v48
    v_cvt_pk_bf16_f32 v49, 0, v49
    v_mul_f32 v48, v48, v51
    v_mul_f32 v49, v49, v51
    v_cvt_pk_bf16_f32 v23, v48, v49
    s_waitcnt lgkmcnt(0)
    s_add_u32 s12, s72, 0x9e3779b9
    v_mov_b32 v9, s12
    v_mov_b32 v11, s12
    v_mov_b32 v13, s12
    v_mov_b32 v15, s12
    v_perm_b32 v52, v16, v16, v232
    v_perm_b32 v53, v16, v16, v233
    v_perm_b32 v54, v16, v16, v234
    v_perm_b32 v55, v16, v16, v235
    v_perm_b32 v56, v16, v16, v236
    v_perm_b32 v57, v16, v16, v237
    v_perm_b32 v58, v16, v16, v238
    v_perm_b32 v59, v16, v16, v239
    s_waitcnt vmcnt(15)
    v_mfma_f32_16x16x32_bf16 v[60:63], v[52:55], v[72:75], 0
    v_perm_b32 v52, v17, v17, v232
    v_perm_b32 v53, v17, v17, v233
    v_perm_b32 v54, v17, v17, v234
    v_perm_b32 v55, v17, v17, v235
    s_waitcnt vmcnt(14)
    v_mfma_f32_16x16x32_bf16 v[60:63], v[56:59], v[76:79], v[60:63]
    v_perm_b32 v56, v17, v17, v236
    v_perm_b32 v57, v17, v17, v237
    v_perm_b32 v58, v17, v17, v238
    v_perm_b32 v59, v17, v17, v239
    s_waitcnt vmcnt(13)
    v_mfma_f32_16x16x32_bf16 v[60:63], v[52:55], v[80:83], v[60:63]
    v_perm_b32 v52, v18, v18, v232
    v_perm_b32 v53, v18, v18, v233
    v_perm_b32 v54, v18, v18, v234
    v_perm_b32 v55, v18, v18, v235
    s_waitcnt vmcnt(12)
    v_mfma_f32_16x16x32_bf16 v[60:63], v[56:59], v[84:87], v[60:63]
    v_perm_b32 v56, v18, v18, v236
    v_perm_b32 v57, v18, v18, v237
    v_perm_b32 v58, v18, v18, v238
    v_perm_b32 v59, v18, v18, v239
    s_waitcnt vmcnt(11)
    v_mfma_f32_16x16x32_bf16 v[60:63], v[52:55], v[88:91], v[60:63]
    v_perm_b32 v52, v19, v19, v232
    v_perm_b32 v53, v19, v19, v233
    v_perm_b32 v54, v19, v19, v234
    v_perm_b32 v55, v19, v19, v235
    s_waitcnt vmcnt(10)
    v_mfma_f32_16x16x32_bf16 v[60:63], v[56:59], v[92:95], v[60:63]
    v_perm_b32 v56, v19, v19, v236
    v_perm_b32 v57, v19, v19, v237
    v_perm_b32 v58, v19, v19, v238
    v_perm_b32 v59, v19, v19, v239
    s_waitcnt vmcnt(9)
    v_mfma_f32_16x16x32_bf16 v[60:63], v[52:55], v[96:99], v[60:63]
    v_perm_b32 v52, v20, v20, v232
    v_perm_b32 v53, v20, v20, v233
    v_perm_b32 v54, v20, v20, v234
    v_perm_b32 v55, v20, v20, v235
    s_waitcnt vmcnt(8)
    v_mfma_f32_16x16x32_bf16 v[60:63], v[56:59], v[100:103], v[60:63]
    v_perm_b32 v56, v20, v20, v236
    v_perm_b32 v57, v20, v20, v237
    v_perm_b32 v58, v20, v20, v238
    v_perm_b32 v59, v20, v20, v239
    s_waitcnt vmcnt(7)
    v_mfma_f32_16x16x32_bf16 v[60:63], v[52:55], v[104:107], v[60:63]
    v_perm_b32 v52, v21, v21, v232
    v_perm_b32 v53, v21, v21, v233
    v_perm_b32 v54, v21, v21, v234
    v_perm_b32 v55, v21, v21, v235
    s_waitcnt vmcnt(6)
    v_mfma_f32_16x16x32_bf16 v[60:63], v[56:59], v[108:111], v[60:63]
    v_perm_b32 v56, v21, v21, v236
    v_perm_b32 v57, v21, v21, v237
    v_perm_b32 v58, v21, v21, v238
    v_perm_b32 v59, v21, v21, v239
    s_waitcnt vmcnt(5)
    v_mfma_f32_16x16x32_bf16 v[60:63], v[52:55], v[112:115], v[60:63]
    v_perm_b32 v52, v22, v22, v232
    v_perm_b32 v53, v22, v22, v233
    v_perm_b32 v54, v22, v22, v234
    v_perm_b32 v55, v22, v22, v235
    s_waitcnt vmcnt(4)
    v_mfma_f32_16x16x32_bf16 v[60:63], v[56:59], v[116:119], v[60:63]
    v_perm_b32 v56, v22, v22, v236
    v_perm_b32 v57, v22, v22, v237
    v_perm_b32 v58, v22, v22, v238
    v_perm_b32 v59, v22, v22, v239
    s_waitcnt vmcnt(3)
    v_mfma_f32_16x16x32_bf16 v[60:63], v[52:55], v[120:123], v[60:63]
    v_perm_b32 v52, v23, v23, v232
    v_perm_b32 v53, v23, v23, v233
    v_perm_b32 v54, v23, v23, v234
    v_perm_b32 v55, v23, v23, v235
    s_waitcnt vmcnt(2)
    v_mfma_f32_16x16x32_bf16 v[60:63], v[56:59], v[124:127], v[60:63]
    v_perm_b32 v56, v23, v23, v236
    v_perm_b32 v57, v23, v23, v237
    v_perm_b32 v58, v23, v23, v238
    v_perm_b32 v59, v23, v23, v239
    s_waitcnt vmcnt(1)
    v_mfma_f32_16x16x32_bf16 v[60:63], v[52:55], v[128:131], v[60:63]
    s_nop 1
    s_waitcnt vmcnt(0)
    v_mfma_f32_16x16x32_bf16 v[60:63], v[56:59], v[132:135], v[60:63]
    s_nop 7
    v_mov_b32 v8, v60
    v_mov_b32 v10, v61
    v_mov_b32 v12, v62
    v_mov_b32 v14, v63
    buffer_store_dwordx4 v[8:11], v4, s[52:55], s13 offen sc1
    buffer_store_dwordx4 v[12:15], v4, s[52:55], s13 offen offset:1024 sc1
    s_branch L_noqld
L_noprod:
    s_barrier
    s_cmp_ge_u32 s2, 32
    s_cbranch_scc1 L_noqld
    s_cmp_ge_u32 s3, 2
    s_cbranch_scc1 L_noqld
    v_lshrrev_b32 v4, 5, v1
    v_lshlrev_b32 v4, 10, v4
    v_and_b32 v7, 31, v1
    v_lshl_add_u32 v4, v7, 4, v4
    v_add_u32 v42, 0x1000, v4
    s_lshl_b32 s13, s2, 14
    s_lshl_b32 s12, s3, 9
    s_add_u32 s13, s13, s12
    s_add_u32 s13, s13, 0x100000
    s_add_u32 s12, s13, 0x2000
    s_waitcnt lgkmcnt(0)
    s_add_u32 s72, s72, 0x9e3779b9
    s_mov_b64 s[78:79], -1
    s_mov_b64 s[80:81], -1
    s_mov_b64 s[82:83], -1
    s_mov_b64 s[84:85], -1
L_poll_2:
    s_mov_b64 exec, s[78:79]
    s_cbranch_execz L_psk_3
    buffer_load_dwordx4 v[8:11], v4, s[52:55], s13 offen offset:0 sc1
    buffer_load_dwordx4 v[12:15], v4, s[52:55], s13 offen offset:2048 sc1
L_psk_3:
    s_mov_b64 exec, s[80:81]
    s_cbranch_execz L_psk_4
    buffer_load_dwordx4 v[16:19], v42, s[52:55], s13 offen offset:0 sc1
    buffer_load_dwordx4 v[20:23], v42, s[52:55], s13 offen offset:2048 sc1
L_psk_4:
    s_mov_b64 exec, s[82:83]
    s_cbranch_execz L_psk_5
    buffer_load_dwordx4 v[24:27], v4, s[52:55], s12 offen offset:0 sc1
    buffer_load_dwordx4 v[28:31], v4, s[52:55], s12 offen offset:2048 sc1
L_psk_5:
    s_mov_b64 exec, s[84:85]
    s_cbranch_execz L_psk_6
    buffer_load_dwordx4 v[32:35], v42, s[52:55], s12 offen offset:0 sc1
    buffer_load_dwordx4 v[36:39], v42, s[52:55], s12 offen offset:2048 sc1
L_psk_6:
    s_mov_b64 exec, -1
    s_waitcnt vmcnt(0)
    v_xor_b32 v40, s72, v9
    v_xor_b32 v41, s72, v11
    v_or_b32 v40, v40, v41
    v_xor_b32 v41, s72, v13
    v_or_b32 v40, v40, v41
    v_xor_b32 v41, s72, v15
    v_or_b32 v40, v40, v41
    v_cmp_ne_u32 s[78:79], 0, v40
    v_xor_b32 v40, s72, v17
    v_xor_b32 v41, s72, v19
    v_or_b32 v40, v40, v41
    v_xor_b32 v41, s72, v21
    v_or_b32 v40, v40, v41
    v_xor_b32 v41, s72, v23
    v_or_b32 v40, v40, v41
    v_cmp_ne_u32 s[80:81], 0, v40
    v_xor_b32 v40, s72, v25
    v_xor_b32 v41, s72, v27
    v_or_b32 v40, v40, v41
    v_xor_b32 v41, s72, v29
    v_or_b32 v40, v40, v41
    v_xor_b32 v41, s72, v31
    v_or_b32 v40, v40, v41
    v_cmp_ne_u32 s[82:83], 0, v40
    v_xor_b32 v40, s72, v33
    v_xor_b32 v41, s72, v35
    v_or_b32 v40, v40, v41
    v_xor_b32 v41, s72, v37
    v_or_b32 v40, v40, v41
    v_xor_b32 v41, s72, v39
    v_or_b32 v40, v40, v41
    v_cmp_ne_u32 s[84:85], 0, v40
    s_nop 0
    s_mov_b64 vcc, s[78:79]
    s_or_b64 vcc, vcc, s[80:81]
    s_or_b64 vcc, vcc, s[82:83]
    s_or_b64 vcc, vcc, s[84:85]
    s_cmp_eq_u64 vcc, 0
    s_cbranch_scc1 L_pdone_1
    s_sub_u32 s75, s75, 1
    s_cbranch_scc1 L_exit
    s_sleep 8
    s_branch L_poll_2
L_pdone_1:
    v_add_f32 v8, v8, v12
    v_add_f32 v10, v10, v14
    v_add_f32 v8, v8, v16
    v_add_f32 v10, v10, v18
    v_add_f32 v8, v8, v20
    v_add_f32 v10, v10, v22
    v_add_f32 v8, v8, v24
    v_add_f32 v10, v10, v26
    v_add_f32 v8, v8, v28
    v_add_f32 v10, v10, v30
    v_add_f32 v8, v8, v32
    v_add_f32 v10, v10, v34
    v_add_f32 v8, v8, v36
    v_add_f32 v10, v10, v38
    v_lshlrev_b32 v4, 5, v3
    v_and_b32 v7, 1, v2
    v_lshl_add_u32 v4, v7, 4, v4
    v_lshrrev_b32 v7, 1, v2
    v_lshl_add_u32 v4, v7, 3, v4
    s_lshl_b32 s13, s3, 14
    s_lshl_b32 s12, s2, 9
    s_add_u32 s13, s13, s12
    s_add_u32 s13, s13, 0x2000
    v_cvt_pk_bf16_f32 v8, v8, v10
    buffer_store_dwordx2 v[8:9], v4, s[52:55], s13 offen sc1
    s_sub_u32 s72, s72, 0x9e3779b9
L_noqld:
    s_cmp_lg_u32 s73, 3
    s_cbranch_scc1 L_idx
    s_sub_u32 s76, s2, 64
L_idx:
    s_mov_b32 s68, s34
    s_and_b32 s69, s35, 0xffff
    s_mov_b32 s70, 0x800
    s_mov_b32 s71, 0x00020000
    s_cmp_lg_u32 s3, 3
    s_cbranch_scc1 L_noclean
    v_mov_b32 v8, -1
    v_mov_b32 v9, -1
    v_mov_b32 v10, -1
    v_mov_b32 v11, -1
    s_lshl_b32 s12, s9, 5
    s_lshl_b32 s13, s8, 2
    s_add_u32 s12, s12, s13
    s_lshl_b32 s13, s12, 13
    s_lshl_b32 vcc_lo, s10, 9
    s_add_u32 s13, s13, vcc_lo
    s_add_u32 s13, s13, 0x80000
    s_lshl_b32 s12, s12, 7
    s_lshl_b32 vcc_lo, s10, 3
    s_add_u32 s12, s12, vcc_lo
    s_add_u32 s12, s12, 0xa000
    v_lshrrev_b32 v4, 5, v1
    v_lshlrev_b32 v4, 13, v4
    v_and_b32 v7, 31, v1
    v_lshl_add_u32 v4, v7, 4, v4
    buffer_store_dwordx4 v[8:11], v4, s[52:55], s13 offen sc1
    s_add_u32 s13, s13, 0x4000
    buffer_store_dwordx4 v[8:11], v4, s[52:55], s13 offen sc1
    v_and_b32 v4, 3, v1
    v_lshlrev_b32 v4, 7, v4
    buffer_store_dwordx2 v[8:9], v4, s[52:55], s12 offen sc1
    s_cmp_eq_u32 s73, 2
    s_cbranch_scc0 L_cl_n2
    v_lshrrev_b32 v4, 1, v2
    v_lshlrev_b32 v4, 11, v4
    v_lshl_add_u32 v4, v3, 5, v4
    v_and_b32 v7, 1, v2
    v_lshl_add_u32 v4, v7, 4, v4
    s_lshl_b32 s13, s8, 12
    s_lshl_b32 s12, s76, 9
    s_add_u32 s13, s13, s12
    s_add_u32 s13, s13, 0xc000
    buffer_store_dwordx4 v[8:11], v4, s[52:55], s13 offen sc1
L_cl_n2:
    s_cmp_eq_u32 s73, 3
    s_cbranch_scc0 L_cl_n3
    v_lshlrev_b32 v4, 4, v1
    s_lshl_b32 s13, s76, 12
    s_add_u32 s13, s13, 0x20000
    buffer_store_dwordx4 v[8:11], v4, s[52:55], s13 offen offset:0 sc1
    buffer_store_dwordx4 v[8:11], v4, s[52:55], s13 offen offset:1024 sc1
    buffer_store_dwordx4 v[8:11], v4, s[52:55], s13 offen offset:2048 sc1
    buffer_store_dwordx4 v[8:11], v4, s[52:55], s13 offen offset:3072 sc1
L_cl_n3:
    s_cmp_ge_u32 s2, 16
    s_cbranch_scc1 L_cl_n4
    v_mov_b32 v4, 0
    s_lshl_b32 s13, s2, 8
    s_add_u32 s13, s13, 0x18000
    buffer_store_dword v4, v4, s[52:55], s13 offen sc1
L_cl_n4:
    s_lshl_b32 s13, s2, 2
    s_add_u32 s13, s13, 0x1000
    v_mov_b32 v4, 0
    s_waitcnt vmcnt(0) lgkmcnt(0)
    s_add_u32 s12, s72, 0x9e3779b9
    v_mov_b32 v8, s12
    s_mov_b64 exec, 1
    buffer_store_dword v8, v4, s[52:55], s13 offen sc1
    s_mov_b64 exec, -1
L_noclean:
    s_mov_b32 s48, s24
    s_and_b32 s49, s25, 0xffff
    s_mov_b32 s50, 0x400000
    s_mov_b32 s51, 0x00020000
    s_mov_b32 s56, s30
    s_and_b32 s57, s31, 0xffff
    s_mov_b32 s58, 0x1c0000
    s_mov_b32 s59, 0x00020000
    s_mov_b32 s60, s32
    s_and_b32 s61, s33, 0xffff
    s_mov_b32 s62, 0x1c0000
    s_mov_b32 s63, 0x00020000
    s_cmp_lg_u32 s73, 3
    s_cbranch_scc1 L_ring
    s_mov_b32 s48, s28
    s_and_b32 s49, s29, 0xffff
    s_mov_b32 s50, 0x1c0000
    s_mov_b32 s51, 0x00020000
L_ring:
    s_and_b32 s25, s2, 15
    s_mul_i32 s25, s25, 0xc8000
    s_add_u32 s20, s20, s25
    s_mov_b32 s22, s20
    s_mov_b32 s24, s21
    s_mov_b32 s23, s21
    s_mov_b32 s16, -1
    s_mov_b32 s17, -1
    s_mov_b32 s18, -1
    s_mov_b32 s19, 0
    s_waitcnt lgkmcnt(0)
    s_add_u32 s72, s72, 0x9e3779b9
    s_cmp_eq_u32 s3, 2
    s_cbranch_scc1 L_qg
    s_setprio 0
L_ring2:
    s_and_b32 s12, s2, 15
    s_lshl_b32 s12, s12, 2
    s_add_u32 s12, s12, 0x1000
    v_mov_b32 v4, 0
    v_not_b32 v244, s72
    s_cmp_ge_u32 s3, 3
    s_cbranch_scc1 L_y_7
    s_mov_b64 exec, 1
    ds_add_rtn_u32 v69, v70, v71
    s_mov_b64 exec, -1
    s_waitcnt lgkmcnt(0)
    v_readfirstlane_b32 s14, v69
    s_nop 0
    s_cmp_lt_u32 s14, s23
    s_cbranch_scc1 L_df_9
    s_sub_u32 s14, s14, s24
    s_lshr_b32 s12, s14, 13
    s_lshl_b32 s12, s12, 2
    v_mov_b32 v4, s12
    s_and_b32 s14, s14, 0x1fff
L_sp_11:
    ds_read_b32 v7, v4 offset:17680
    s_sub_u32 s75, s75, 1
    s_cbranch_scc1 L_exit
    s_waitcnt lgkmcnt(0)
    v_readfirstlane_b32 s12, v7
    s_cmp_eq_u32 s12, 0xfffffffe
    s_cbranch_scc1 L_sp_11
    s_add_u32 s14, s14, s12
    s_branch L_dd_10
L_df_9:
    s_add_u32 s14, s14, s22
    s_and_b32 s14, s14, 0x7fffff
L_dd_10:
    s_branch L_j_8
L_y_7:
    s_mov_b32 s14, 0x40000000
L_cd_12:
    ds_read_b64 v[8:9], v70
    s_waitcnt lgkmcnt(0)
    v_readfirstlane_b32 s12, v9
    v_readfirstlane_b32 s13, v8
    v_add_u32 v9, 0x1000, v8
    s_lshl_b32 s12, s12, 31
    s_or_b32 s12, s12, s13
    s_cmp_ge_u32 s12, 0x40000
    s_cbranch_scc1 L_j_8
    s_mov_b64 exec, 1
    ds_cmpst_rtn_b32 v69, v70, v8, v9
    s_mov_b64 exec, -1
    s_waitcnt lgkmcnt(0)
    v_readfirstlane_b32 s12, v69
    s_nop 0
    s_cmp_lg_u32 s12, s13
    s_cbranch_scc1 L_cd_12
    s_add_u32 s14, s13, s22
    s_and_b32 s14, s14, 0x7fffff
L_j_8:
    buffer_load_dwordx4 v[72:75], v5, s[40:43], s14 offen offset:0 nt
    buffer_load_dwordx4 v[76:79], v5, s[40:43], s14 offen offset:64 nt
    buffer_load_dwordx4 v[80:83], v5, s[40:43], s14 offen offset:128 nt
    buffer_load_dwordx4 v[84:87], v5, s[40:43], s14 offen offset:192 nt
    buffer_load_dwordx4 v[88:91], v6, s[44:47], s14 offen offset:0 nt
    buffer_load_dwordx4 v[92:95], v6, s[44:47], s14 offen offset:1024 nt
    buffer_load_dwordx4 v[96:99], v6, s[44:47], s14 offen offset:2048 nt
    buffer_load_dwordx4 v[100:103], v6, s[44:47], s14 offen offset:3072 nt
    s_cmp_ge_u32 s3, 3
    s_cbranch_scc1 L_y_13
    s_mov_b64 exec, 1
    ds_add_rtn_u32 v69, v70, v71
    s_mov_b64 exec, -1
    s_waitcnt lgkmcnt(0)
    v_readfirstlane_b32 s15, v69
    s_nop 0
    s_cmp_lt_u32 s15, s23
    s_cbranch_scc1 L_df_15
    s_sub_u32 s15, s15, s24
    s_lshr_b32 s12, s15, 13
    s_lshl_b32 s12, s12, 2
    v_mov_b32 v4, s12
    s_and_b32 s15, s15, 0x1fff
L_sp_17:
    ds_read_b32 v7, v4 offset:17680
    s_sub_u32 s75, s75, 1
    s_cbranch_scc1 L_exit
    s_waitcnt lgkmcnt(0)
    v_readfirstlane_b32 s12, v7
    s_cmp_eq_u32 s12, 0xfffffffe
    s_cbranch_scc1 L_sp_17
    s_add_u32 s15, s15, s12
    s_branch L_dd_16
L_df_15:
    s_add_u32 s15, s15, s22
    s_and_b32 s15, s15, 0x7fffff
L_dd_16:
    s_branch L_j_14
L_y_13:
    s_mov_b32 s15, 0x40000000
L_cd_18:
    ds_read_b64 v[8:9], v70
    s_waitcnt lgkmcnt(0)
    v_readfirstlane_b32 s12, v9
    v_readfirstlane_b32 s13, v8
    v_add_u32 v9, 0x1000, v8
    s_lshl_b32 s12, s12, 31
    s_or_b32 s12, s12, s13
    s_cmp_ge_u32 s12, 0x40000
    s_cbranch_scc1 L_j_14
    s_mov_b64 exec, 1
    ds_cmpst_rtn_b32 v69, v70, v8, v9
    s_mov_b64 exec, -1
    s_waitcnt lgkmcnt(0)
    v_readfirstlane_b32 s12, v69
    s_nop 0
    s_cmp_lg_u32 s12, s13
    s_cbranch_scc1 L_cd_18
    s_add_u32 s15, s13, s22
    s_and_b32 s15, s15, 0x7fffff
L_j_14:
    buffer_load_dwordx4 v[104:107], v5, s[40:43], s15 offen offset:0 nt
    buffer_load_dwordx4 v[108:111], v5, s[40:43], s15 offen offset:64 nt
    buffer_load_dwordx4 v[112:115], v5, s[40:43], s15 offen offset:128 nt
    buffer_load_dwordx4 v[116:119], v5, s[40:43], s15 offen offset:192 nt
    buffer_load_dwordx4 v[120:123], v6, s[44:47], s15 offen offset:0 nt
    buffer_load_dwordx4 v[124:127], v6, s[44:47], s15 offen offset:1024 nt
    buffer_load_dwordx4 v[128:131], v6, s[44:47], s15 offen offset:2048 nt
    buffer_load_dwordx4 v[132:135], v6, s[44:47], s15 offen offset:3072 nt
L_cd_19:
    ds_read_b64 v[8:9], v70
    s_waitcnt lgkmcnt(0)
    v_readfirstlane_b32 s12, v9
    v_readfirstlane_b32 s13, v8
    v_add_u32 v9, 0x1000, v8
    s_lshl_b32 s12, s12, 31
    s_or_b32 s12, s12, s13
    s_cmp_ge_u32 s12, 0x40000
    s_cbranch_scc1 L_waitq
    s_mov_b64 exec, 1
    ds_cmpst_rtn_b32 v69, v70, v8, v9
    s_mov_b64 exec, -1
    s_waitcnt lgkmcnt(0)
    v_readfirstlane_b32 s12, v69
    s_nop 0
    s_cmp_lg_u32 s12, s13
    s_cbranch_scc1 L_cd_19
    s_add_u32 s16, s13, s22
    s_and_b32 s16, s16, 0x7fffff
    s_mov_b32 s19, 1
    buffer_load_dwordx4 v[136:139], v5, s[40:43], s16 offen offset:0 nt
    buffer_load_dwordx4 v[140:143], v5, s[40:43], s16 offen offset:64 nt
    buffer_load_dwordx4 v[144:147], v5, s[40:43], s16 offen offset:128 nt
    buffer_load_dwordx4 v[148:151], v5, s[40:43], s16 offen offset:192 nt
    buffer_load_dwordx4 v[152:155], v6, s[44:47], s16 offen offset:0 nt
    buffer_load_dwordx4 v[156:159], v6, s[44:47], s16 offen offset:1024 nt
    buffer_load_dwordx4 v[160:163], v6, s[44:47], s16 offen offset:2048 nt
    buffer_load_dwordx4 v[164:167], v6, s[44:47], s16 offen offset:3072 nt
L_cd_20:
    ds_read_b64 v[8:9], v70
    s_waitcnt lgkmcnt(0)
    v_readfirstlane_b32 s12, v9
    v_readfirstlane_b32 s13, v8
    v_add_u32 v9, 0x1000, v8
    s_lshl_b32 s12, s12, 31
    s_or_b32 s12, s12, s13
    s_cmp_ge_u32 s12, 0x40000
    s_cbranch_scc1 L_waitq
    s_mov_b64 exec, 1
    ds_cmpst_rtn_b32 v69, v70, v8, v9
    s_mov_b64 exec, -1
    s_waitcnt lgkmcnt(0)
    v_readfirstlane_b32 s12, v69
    s_nop 0
    s_cmp_lg_u32 s12, s13
    s_cbranch_scc1 L_cd_20
    s_add_u32 s17, s13, s22
    s_and_b32 s17, s17, 0x7fffff
    s_mov_b32 s19, 1
    buffer_load_dwordx4 v[168:171], v5, s[40:43], s17 offen offset:0 nt
    buffer_load_dwordx4 v[172:175], v5, s[40:43], s17 offen offset:64 nt
    buffer_load_dwordx4 v[176:179], v5, s[40:43], s17 offen offset:128 nt
    buffer_load_dwordx4 v[180:183], v5, s[40:43], s17 offen offset:192 nt
    buffer_load_dwordx4 v[184:187], v6, s[44:47], s17 offen offset:0 nt
    buffer_load_dwordx4 v[188:191], v6, s[44:47], s17 offen offset:1024 nt
    buffer_load_dwordx4 v[192:195], v6, s[44:47], s17 offen offset:2048 nt
    buffer_load_dwordx4 v[196:199], v6, s[44:47], s17 offen offset:3072 nt
L_cd_21:
    ds_read_b64 v[8:9], v70
    s_waitcnt lgkmcnt(0)
    v_readfirstlane_b32 s12, v9
    v_readfirstlane_b32 s13, v8
    v_add_u32 v9, 0x1000, v8
    s_lshl_b32 s12, s12, 31
    s_or_b32 s12, s12, s13
    s_cmp_ge_u32 s12, 0x40000
    s_cbranch_scc1 L_waitq
    s_mov_b64 exec, 1
    ds_cmpst_rtn_b32 v69, v70, v8, v9
    s_mov_b64 exec, -1
    s_waitcnt lgkmcnt(0)
    v_readfirstlane_b32 s12, v69
    s_nop 0
    s_cmp_lg_u32 s12, s13
    s_cbranch_scc1 L_cd_21
    s_add_u32 s18, s13, s22
    s_and_b32 s18, s18, 0x7fffff
    s_mov_b32 s19, 1
    buffer_load_dwordx4 v[200:203], v5, s[40:43], s18 offen offset:0 nt
    buffer_load_dwordx4 v[204:207], v5, s[40:43], s18 offen offset:64 nt
    buffer_load_dwordx4 v[208:211], v5, s[40:43], s18 offen offset:128 nt
    buffer_load_dwordx4 v[212:215], v5, s[40:43], s18 offen offset:192 nt
    buffer_load_dwordx4 v[216:219], v6, s[44:47], s18 offen offset:0 nt
    buffer_load_dwordx4 v[220:223], v6, s[44:47], s18 offen offset:1024 nt
    buffer_load_dwordx4 v[224:227], v6, s[44:47], s18 offen offset:2048 nt
    buffer_load_dwordx4 v[228:231], v6, s[44:47], s18 offen offset:3072 nt
L_waitq:
    ds_read_b32 v8, v70 offset:4
    s_waitcnt lgkmcnt(0)
    v_readfirstlane_b32 s12, v8
    s_cmp_lg_u32 s12, 0
    s_cbranch_scc1 L_haveq
    s_sub_u32 s75, s75, 1
    s_cbranch_scc1 L_exit
    s_sleep 2
    s_branch L_waitq
L_qg:
    v_lshlrev_b32 v4, 4, v1
    s_lshl_b32 s13, s9, 14
    s_lshl_b32 s12, s8, 11
    s_add_u32 s13, s13, s12
    s_add_u32 s13, s13, 0x2000
    s_mov_b64 s[78:79], -1
L_poll_23:
    s_mov_b64 exec, s[78:79]
    s_cbranch_execz L_psk_24
    buffer_load_dwordx4 v[8:11], v4, s[52:55], s13 offen offset:0 sc1
    buffer_load_dwordx4 v[12:15], v4, s[52:55], s13 offen offset:1024 sc1
L_psk_24:
    s_mov_b64 exec, -1
    s_waitcnt vmcnt(0)
    v_xor_b32 v16, s72, v9
    v_xor_b32 v17, s72, v11
    v_or_b32 v16, v16, v17
    v_xor_b32 v17, s72, v13
    v_or_b32 v16, v16, v17
    v_xor_b32 v17, s72, v15
    v_or_b32 v16, v16, v17
    v_cmp_ne_u32 s[78:79], 0, v16
    s_nop 0
    s_mov_b64 vcc, s[78:79]
    s_cmp_eq_u64 vcc, 0
    s_cbranch_scc1 L_pdone_22
    s_sub_u32 s75, s75, 1
    s_cbranch_scc1 L_exit
    s_sleep 8
    s_branch L_poll_23
L_pdone_22:
    v_mov_b32 v9, v10
    v_mov_b32 v13, v14
    v_lshlrev_b32 v4, 3, v1
    ds_write_b64 v4, v[8:9] offset:0
    ds_write_b64 v4, v[12:13] offset:512
    v_mov_b32 v8, 1
    s_waitcnt lgkmcnt(0)
    ds_write_b32 v70, v8 offset:4
    s_setprio 0
    s_branch L_ring2
L_haveq:
    v_lshrrev_b32 v4, 2, v3
    v_lshlrev_b32 v4, 8, v4
    v_lshl_add_u32 v4, v2, 4, v4
    ds_read_b128 v[8:11], v4 offset:0
    ds_read_b128 v[12:15], v4 offset:64
    ds_read_b128 v[16:19], v4 offset:128
    ds_read_b128 v[20:23], v4 offset:192
    v_lshlrev_b32 v4, 4, v1
    s_mov_b32 s13, 0x1000
    s_cmp_eq_u32 s73, 0
    s_cbranch_scc1 L_nofl
    v_not_b32 v240, s72
    buffer_load_dwordx4 v[240:243], v4, s[52:55], s13 offen sc1
L_nofl:
    s_and_b32 s12, s2, 15
    s_lshl_b32 s12, s12, 2
    s_add_u32 s12, s12, 0x1000
    v_mov_b32 v4, 0
    buffer_load_dword v244, v4, s[52:55], s12 offen sc1
    v_mov_b32 v32, 0
    v_mov_b32 v33, 0
    v_mov_b32 v36, 0
    v_mov_b32 v37, 0
    v_mov_b32 v40, 0
    v_mov_b32 v41, 0
    v_mov_b32 v44, 0
    v_mov_b32 v45, 0
    v_mov_b32 v48, 0
    v_mov_b32 v49, 0
    v_mov_b32 v24, 0
    v_mov_b32 v25, 0
    v_mov_b32 v26, 0
    v_mov_b32 v27, 0
    v_mov_b32 v28, 0
    v_mov_b32 v29, 0
    v_mov_b32 v30, 0
    v_mov_b32 v31, 0
    v_mov_b32 v60, 0xf149f2ca
    v_mov_b32 v61, 0
    s_mov_b32 s29, 0
    s_cmp_lt_u32 s3, 3
    s_cbranch_scc1 L_nopark
    s_mov_b32 s29, 0x40000000
    s_mov_b32 s23, -1
    v_mov_b32 v71, 0
L_nopark:
    v_and_b32 v64, 1, v3
    v_lshlrev_b32 v64, 4, v64
    v_mov_b32 v65, 0xffff
    v_lshlrev_b32 v65, v64, v65
    v_and_b32 v64, 2, v3
    v_cmp_eq_u32 vcc, 0, v64
    s_nop 1
    v_cndmask_b32 v66, 0, v65, vcc
    v_cndmask_b32 v67, v65, 0, vcc
    s_waitcnt lgkmcnt(0)
.p2align 3
L_loop:
    s_cmp_ge_u32 s14, s42
    s_cbranch_scc1 L_epi
    s_mov_b64 exec, 1
    ds_add_rtn_u32 v69, v70, v71
    s_mov_b64 exec, -1
    s_waitcnt vmcnt(12)
    v_mfma_f32_16x16x32_bf16 v[52:55], v[72:75], v[8:11], 0
    v_mfma_f32_16x16x32_bf16 v[52:55], v[76:79], v[12:15], v[52:55]
    s_waitcnt lgkmcnt(0)
    v_readfirstlane_b32 s14, v69
    v_mfma_f32_16x16x32_bf16 v[52:55], v[80:83], v[16:19], v[52:55]
    v_mfma_f32_16x16x32_bf16 v[52:55], v[84:87], v[20:23], v[52:55]
    s_cmp_ge_u32 s14, s23
    s_cbranch_scc1 L_slow0
    s_add_u32 s14, s14, s22
    s_and_b32 s14, s14, 0x7fffff
    s_or_b32 s14, s14, s29
L_back0:
    buffer_load_dwordx4 v[72:75], v5, s[40:43], s14 offen offset:0 nt
    buffer_load_dwordx4 v[76:79], v5, s[40:43], s14 offen offset:64 nt
    buffer_load_dwordx4 v[80:83], v5, s[40:43], s14 offen offset:128 nt
    buffer_load_dwordx4 v[84:87], v5, s[40:43], s14 offen offset:192 nt
    s_nop 0
    v_cvt_pk_bf16_f32 v56, 0, v52
    v_cvt_pk_bf16_f32 v57, 0, v53
    v_cvt_pk_bf16_f32 v58, 0, v54
    v_cvt_pk_bf16_f32 v59, 0, v55
    v_mul_f32 v56, s5, v56
    v_mul_f32 v57, s5, v57
    v_mul_f32 v58, s5, v58
    v_mul_f32 v59, s5, v59
    v_cvt_pk_bf16_f32 v56, 0, v56
    v_cvt_pk_bf16_f32 v57, 0, v57
    v_cvt_pk_bf16_f32 v58, 0, v58
    v_cvt_pk_bf16_f32 v59, 0, v59
    v_max3_f32 v64, v56, v57, v58
    v_max_f32 v64, v64, v59
    v_mov_b32 v65, v64
    s_nop 1
    v_permlane32_swap_b32 v64, v65
    v_max_f32 v64, v64, v65
    v_mov_b32 v65, v64
    s_nop 1
    v_permlane16_swap_b32 v64, v65
    v_max_f32 v64, v64, v65
    v_mul_f32 v64, s4, v64
    v_max_f32 v68, v60, v64
    v_sub_f32 v62, v60, v68
    v_exp_f32 v62, v62
    v_fma_f32 v56, v56, s4, -v68
    v_fma_f32 v57, v57, s4, -v68
    v_fma_f32 v58, v58, s4, -v68
    v_fma_f32 v59, v59, s4, -v68
    v_mov_b32 v60, v68
    v_exp_f32 v56, v56
    v_exp_f32 v57, v57
    v_exp_f32 v58, v58
    v_exp_f32 v59, v59
    v_mov_b32_dpp v63, v62 row_newbcast:0 row_mask:0x1 bank_mask:0xf
    v_mov_b32_dpp v63, v62 row_newbcast:4 row_mask:0x2 bank_mask:0xf
    v_mov_b32_dpp v63, v62 row_newbcast:8 row_mask:0x4 bank_mask:0xf
    v_mov_b32_dpp v63, v62 row_newbcast:12 row_mask:0x8 bank_mask:0xf
    v_mul_f32 v61, v61, v62
    v_cvt_pk_bf16_f32 v64, v56, v56
    v_and_b32 v34, v64, v66
    v_and_b32 v35, v64, v67
    v_cvt_pk_bf16_f32 v64, v57, v57
    v_and_b32 v38, v64, v66
    v_and_b32 v39, v64, v67
    v_cvt_pk_bf16_f32 v64, v58, v58
    v_and_b32 v42, v64, v66
    v_and_b32 v43, v64, v67
    v_cvt_pk_bf16_f32 v64, v59, v59
    v_and_b32 v46, v64, v66
    v_and_b32 v47, v64, v67
    v_mul_f32 v24, v24, v63
    v_mul_f32 v25, v25, v63
    v_mul_f32 v26, v26, v63
    v_mul_f32 v27, v27, v63
    v_mul_f32 v28, v28, v63
    v_mul_f32 v29, v29, v63
    v_mul_f32 v30, v30, v63
    v_mul_f32 v31, v31, v63
    v_add_f32 v56, v56, v57
    v_add_f32 v58, v58, v59
    v_add_f32 v61, v61, v56
    v_add_f32 v61, v61, v58
    s_waitcnt vmcnt(12)
    v_mfma_f32_16x16x32_bf16 v[24:27], v[34:37], v[88:91], v[24:27]
    v_mfma_f32_16x16x32_bf16 v[28:31], v[32:35], v[88:91], v[28:31]
    v_mfma_f32_16x16x32_bf16 v[24:27], v[38:41], v[92:95], v[24:27]
    v_mfma_f32_16x16x32_bf16 v[28:31], v[36:39], v[92:95], v[28:31]
    v_mfma_f32_16x16x32_bf16 v[24:27], v[42:45], v[96:99], v[24:27]
    v_mfma_f32_16x16x32_bf16 v[28:31], v[40:43], v[96:99], v[28:31]
    v_mfma_f32_16x16x32_bf16 v[24:27], v[46:49], v[100:103], v[24:27]
    v_mfma_f32_16x16x32_bf16 v[28:31], v[44:47], v[100:103], v[28:31]
    buffer_load_dwordx4 v[88:91], v6, s[44:47], s14 offen offset:0 nt
    buffer_load_dwordx4 v[92:95], v6, s[44:47], s14 offen offset:1024 nt
    buffer_load_dwordx4 v[96:99], v6, s[44:47], s14 offen offset:2048 nt
    buffer_load_dwordx4 v[100:103], v6, s[44:47], s14 offen offset:3072 nt
    s_cmp_ge_u32 s15, s42
    s_cbranch_scc1 L_epi
    s_mov_b64 exec, 1
    ds_add_rtn_u32 v69, v70, v71
    s_mov_b64 exec, -1
    s_waitcnt vmcnt(12)
    v_mfma_f32_16x16x32_bf16 v[52:55], v[104:107], v[8:11], 0
    v_mfma_f32_16x16x32_bf16 v[52:55], v[108:111], v[12:15], v[52:55]
    s_waitcnt lgkmcnt(0)
    v_readfirstlane_b32 s15, v69
    v_mfma_f32_16x16x32_bf16 v[52:55], v[112:115], v[16:19], v[52:55]
    v_mfma_f32_16x16x32_bf16 v[52:55], v[116:119], v[20:23], v[52:55]
    s_cmp_ge_u32 s15, s23
    s_cbranch_scc1 L_slow1
    s_add_u32 s15, s15, s22
    s_and_b32 s15, s15, 0x7fffff
    s_or_b32 s15, s15, s29
L_back1:
    buffer_load_dwordx4 v[104:107], v5, s[40:43], s15 offen offset:0 nt
    buffer_load_dwordx4 v[108:111], v5, s[40:43], s15 offen offset:64 nt
    buffer_load_dwordx4 v[112:115], v5, s[40:43], s15 offen offset:128 nt
    buffer_load_dwordx4 v[116:119], v5, s[40:43], s15 offen offset:192 nt
    s_nop 0
    v_cvt_pk_bf16_f32 v56, 0, v52
    v_cvt_pk_bf16_f32 v57, 0, v53
    v_cvt_pk_bf16_f32 v58, 0, v54
    v_cvt_pk_bf16_f32 v59, 0, v55
    v_mul_f32 v56, s5, v56
    v_mul_f32 v57, s5, v57
    v_mul_f32 v58, s5, v58
    v_mul_f32 v59, s5, v59
    v_cvt_pk_bf16_f32 v56, 0, v56
    v_cvt_pk_bf16_f32 v57, 0, v57
    v_cvt_pk_bf16_f32 v58, 0, v58
    v_cvt_pk_bf16_f32 v59, 0, v59
    v_max3_f32 v64, v56, v57, v58
    v_max_f32 v64, v64, v59
    v_mov_b32 v65, v64
    s_nop 1
    v_permlane32_swap_b32 v64, v65
    v_max_f32 v64, v64, v65
    v_mov_b32 v65, v64
    s_nop 1
    v_permlane16_swap_b32 v64, v65
    v_max_f32 v64, v64, v65
    v_mul_f32 v64, s4, v64
    v_max_f32 v68, v60, v64
    v_sub_f32 v62, v60, v68
    v_exp_f32 v62, v62
    v_fma_f32 v56, v56, s4, -v68
    v_fma_f32 v57, v57, s4, -v68
    v_fma_f32 v58, v58, s4, -v68
    v_fma_f32 v59, v59, s4, -v68
    v_mov_b32 v60, v68
    v_exp_f32 v56, v56
    v_exp_f32 v57, v57
    v_exp_f32 v58, v58
    v_exp_f32 v59, v59
    v_mov_b32_dpp v63, v62 row_newbcast:0 row_mask:0x1 bank_mask:0xf
    v_mov_b32_dpp v63, v62 row_newbcast:4 row_mask:0x2 bank_mask:0xf
    v_mov_b32_dpp v63, v62 row_newbcast:8 row_mask:0x4 bank_mask:0xf
    v_mov_b32_dpp v63, v62 row_newbcast:12 row_mask:0x8 bank_mask:0xf
    v_mul_f32 v61, v61, v62
    v_cvt_pk_bf16_f32 v64, v56, v56
    v_and_b32 v34, v64, v66
    v_and_b32 v35, v64, v67
    v_cvt_pk_bf16_f32 v64, v57, v57
    v_and_b32 v38, v64, v66
    v_and_b32 v39, v64, v67
    v_cvt_pk_bf16_f32 v64, v58, v58
    v_and_b32 v42, v64, v66
    v_and_b32 v43, v64, v67
    v_cvt_pk_bf16_f32 v64, v59, v59
    v_and_b32 v46, v64, v66
    v_and_b32 v47, v64, v67
    v_mul_f32 v24, v24, v63
    v_mul_f32 v25, v25, v63
    v_mul_f32 v26, v26, v63
    v_mul_f32 v27, v27, v63
    v_mul_f32 v28, v28, v63
    v_mul_f32 v29, v29, v63
    v_mul_f32 v30, v30, v63
    v_mul_f32 v31, v31, v63
    v_add_f32 v56, v56, v57
    v_add_f32 v58, v58, v59
    v_add_f32 v61, v61, v56
    v_add_f32 v61, v61, v58
    s_waitcnt vmcnt(12)
    v_mfma_f32_16x16x32_bf16 v[24:27], v[34:37], v[120:123], v[24:27]
    v_mfma_f32_16x16x32_bf16 v[28:31], v[32:35], v[120:123], v[28:31]
    v_mfma_f32_16x16x32_bf16 v[24:27], v[38:41], v[124:127], v[24:27]
    v_mfma_f32_16x16x32_bf16 v[28:31], v[36:39], v[124:127], v[28:31]
    v_mfma_f32_16x16x32_bf16 v[24:27], v[42:45], v[128:131], v[24:27]
    v_mfma_f32_16x16x32_bf16 v[28:31], v[40:43], v[128:131], v[28:31]
    v_mfma_f32_16x16x32_bf16 v[24:27], v[46:49], v[132:135], v[24:27]
    v_mfma_f32_16x16x32_bf16 v[28:31], v[44:47], v[132:135], v[28:31]
    buffer_load_dwordx4 v[120:123], v6, s[44:47], s15 offen offset:0 nt
    buffer_load_dwordx4 v[124:127], v6, s[44:47], s15 offen offset:1024 nt
    buffer_load_dwordx4 v[128:131], v6, s[44:47], s15 offen offset:2048 nt
    buffer_load_dwordx4 v[132:135], v6, s[44:47], s15 offen offset:3072 nt
    s_cmp_eq_u32 s19, 0
    s_cbranch_scc1 L_loop
    s_waitcnt vmcnt(16)
L_edisp:
    s_mov_b32 s19, 0
    s_cmp_ge_u32 s16, s42
    s_cbranch_scc1 L_loop
    v_mfma_f32_16x16x32_bf16 v[52:55], v[136:139], v[8:11], 0
    v_mfma_f32_16x16x32_bf16 v[52:55], v[140:143], v[12:15], v[52:55]
    v_mfma_f32_16x16x32_bf16 v[52:55], v[144:147], v[16:19], v[52:55]
    v_mfma_f32_16x16x32_bf16 v[52:55], v[148:151], v[20:23], v[52:55]
    s_nop 7
    v_cvt_pk_bf16_f32 v56, 0, v52
    v_cvt_pk_bf16_f32 v57, 0, v53
    v_cvt_pk_bf16_f32 v58, 0, v54
    v_cvt_pk_bf16_f32 v59, 0, v55
    v_mul_f32 v56, s5, v56
    v_mul_f32 v57, s5, v57
    v_mul_f32 v58, s5, v58
    v_mul_f32 v59, s5, v59
    v_cvt_pk_bf16_f32 v56, 0, v56
    v_cvt_pk_bf16_f32 v57, 0, v57
    v_cvt_pk_bf16_f32 v58, 0, v58
    v_cvt_pk_bf16_f32 v59, 0, v59
    v_max3_f32 v64, v56, v57, v58
    v_max_f32 v64, v64, v59
    v_mov_b32 v65, v64
    s_nop 1
    v_permlane32_swap_b32 v64, v65
    v_max_f32 v64, v64, v65
    v_mov_b32 v65, v64
    s_nop 1
    v_permlane16_swap_b32 v64, v65
    v_max_f32 v64, v64, v65
    v_mul_f32 v64, s4, v64
    v_max_f32 v68, v60, v64
    v_sub_f32 v62, v60, v68
    v_exp_f32 v62, v62
    v_fma_f32 v56, v56, s4, -v68
    v_fma_f32 v57, v57, s4, -v68
    v_fma_f32 v58, v58, s4, -v68
    v_fma_f32 v59, v59, s4, -v68
    v_mov_b32 v60, v68
    v_exp_f32 v56, v56
    v_exp_f32 v57, v57
    v_exp_f32 v58, v58
    v_exp_f32 v59, v59
    v_mov_b32_dpp v63, v62 row_newbcast:0 row_mask:0x1 bank_mask:0xf
    v_mov_b32_dpp v63, v62 row_newbcast:4 row_mask:0x2 bank_mask:0xf
    v_mov_b32_dpp v63, v62 row_newbcast:8 row_mask:0x4 bank_mask:0xf
    v_mov_b32_dpp v63, v62 row_newbcast:12 row_mask:0x8 bank_mask:0xf
    v_mul_f32 v61, v61, v62
    v_cvt_pk_bf16_f32 v64, v56, v56
    v_and_b32 v34, v64, v66
    v_and_b32 v35, v64, v67
    v_cvt_pk_bf16_f32 v64, v57, v57
    v_and_b32 v38, v64, v66
    v_and_b32 v39, v64, v67
    v_cvt_pk_bf16_f32 v64, v58, v58
    v_and_b32 v42, v64, v66
    v_and_b32 v43, v64, v67
    v_cvt_pk_bf16_f32 v64, v59, v59
    v_and_b32 v46, v64, v66
    v_and_b32 v47, v64, v67
    v_mul_f32 v24, v24, v63
    v_mul_f32 v25, v25, v63
    v_mul_f32 v26, v26, v63
    v_mul_f32 v27, v27, v63
    v_mul_f32 v28, v28, v63
    v_mul_f32 v29, v29, v63
    v_mul_f32 v30, v30, v63
    v_mul_f32 v31, v31, v63
    v_add_f32 v56, v56, v57
    v_add_f32 v58, v58, v59
    v_add_f32 v61, v61, v56
    v_add_f32 v61, v61, v58
    v_mfma_f32_16x16x32_bf16 v[24:27], v[34:37], v[152:155], v[24:27]
    v_mfma_f32_16x16x32_bf16 v[28:31], v[32:35], v[152:155], v[28:31]
    v_mfma_f32_16x16x32_bf16 v[24:27], v[38:41], v[156:159], v[24:27]
    v_mfma_f32_16x16x32_bf16 v[28:31], v[36:39], v[156:159], v[28:31]
    v_mfma_f32_16x16x32_bf16 v[24:27], v[42:45], v[160:163], v[24:27]
    v_mfma_f32_16x16x32_bf16 v[28:31], v[40:43], v[160:163], v[28:31]
    v_mfma_f32_16x16x32_bf16 v[24:27], v[46:49], v[164:167], v[24:27]
    v_mfma_f32_16x16x32_bf16 v[28:31], v[44:47], v[164:167], v[28:31]
    s_cmp_ge_u32 s17, s42
    s_cbranch_scc1 L_loop
    v_mfma_f32_16x16x32_bf16 v[52:55], v[168:171], v[8:11], 0
    v_mfma_f32_16x16x32_bf16 v[52:55], v[172:175], v[12:15], v[52:55]
    v_mfma_f32_16x16x32_bf16 v[52:55], v[176:179], v[16:19], v[52:55]
    v_mfma_f32_16x16x32_bf16 v[52:55], v[180:183], v[20:23], v[52:55]
    s_nop 7
    v_cvt_pk_bf16_f32 v56, 0, v52
    v_cvt_pk_bf16_f32 v57, 0, v53
    v_cvt_pk_bf16_f32 v58, 0, v54
    v_cvt_pk_bf16_f32 v59, 0, v55
    v_mul_f32 v56, s5, v56
    v_mul_f32 v57, s5, v57
    v_mul_f32 v58, s5, v58
    v_mul_f32 v59, s5, v59
    v_cvt_pk_bf16_f32 v56, 0, v56
    v_cvt_pk_bf16_f32 v57, 0, v57
    v_cvt_pk_bf16_f32 v58, 0, v58
    v_cvt_pk_bf16_f32 v59, 0, v59
    v_max3_f32 v64, v56, v57, v58
    v_max_f32 v64, v64, v59
    v_mov_b32 v65, v64
    s_nop 1
    v_permlane32_swap_b32 v64, v65
    v_max_f32 v64, v64, v65
    v_mov_b32 v65, v64
    s_nop 1
    v_permlane16_swap_b32 v64, v65
    v_max_f32 v64, v64, v65
    v_mul_f32 v64, s4, v64
    v_max_f32 v68, v60, v64
    v_sub_f32 v62, v60, v68
    v_exp_f32 v62, v62
    v_fma_f32 v56, v56, s4, -v68
    v_fma_f32 v57, v57, s4, -v68
    v_fma_f32 v58, v58, s4, -v68
    v_fma_f32 v59, v59, s4, -v68
    v_mov_b32 v60, v68
    v_exp_f32 v56, v56
    v_exp_f32 v57, v57
    v_exp_f32 v58, v58
    v_exp_f32 v59, v59
    v_mov_b32_dpp v63, v62 row_newbcast:0 row_mask:0x1 bank_mask:0xf
    v_mov_b32_dpp v63, v62 row_newbcast:4 row_mask:0x2 bank_mask:0xf
    v_mov_b32_dpp v63, v62 row_newbcast:8 row_mask:0x4 bank_mask:0xf
    v_mov_b32_dpp v63, v62 row_newbcast:12 row_mask:0x8 bank_mask:0xf
    v_mul_f32 v61, v61, v62
    v_cvt_pk_bf16_f32 v64, v56, v56
    v_and_b32 v34, v64, v66
    v_and_b32 v35, v64, v67
    v_cvt_pk_bf16_f32 v64, v57, v57
    v_and_b32 v38, v64, v66
    v_and_b32 v39, v64, v67
    v_cvt_pk_bf16_f32 v64, v58, v58
    v_and_b32 v42, v64, v66
    v_and_b32 v43, v64, v67
    v_cvt_pk_bf16_f32 v64, v59, v59
    v_and_b32 v46, v64, v66
    v_and_b32 v47, v64, v67
    v_mul_f32 v24, v24, v63
    v_mul_f32 v25, v25, v63
    v_mul_f32 v26, v26, v63
    v_mul_f32 v27, v27, v63
    v_mul_f32 v28, v28, v63
    v_mul_f32 v29, v29, v63
    v_mul_f32 v30, v30, v63
    v_mul_f32 v31, v31, v63
    v_add_f32 v56, v56, v57
    v_add_f32 v58, v58, v59
    v_add_f32 v61, v61, v56
    v_add_f32 v61, v61, v58
    v_mfma_f32_16x16x32_bf16 v[24:27], v[34:37], v[184:187], v[24:27]
    v_mfma_f32_16x16x32_bf16 v[28:31], v[32:35], v[184:187], v[28:31]
    v_mfma_f32_16x16x32_bf16 v[24:27], v[38:41], v[188:191], v[24:27]
    v_mfma_f32_16x16x32_bf16 v[28:31], v[36:39], v[188:191], v[28:31]
    v_mfma_f32_16x16x32_bf16 v[24:27], v[42:45], v[192:195], v[24:27]
    v_mfma_f32_16x16x32_bf16 v[28:31], v[40:43], v[192:195], v[28:31]
    v_mfma_f32_16x16x32_bf16 v[24:27], v[46:49], v[196:199], v[24:27]
    v_mfma_f32_16x16x32_bf16 v[28:31], v[44:47], v[196:199], v[28:31]
    s_cmp_ge_u32 s18, s42
    s_cbranch_scc1 L_loop
    v_mfma_f32_16x16x32_bf16 v[52:55], v[200:203], v[8:11], 0
    v_mfma_f32_16x16x32_bf16 v[52:55], v[204:207], v[12:15], v[52:55]
    v_mfma_f32_16x16x32_bf16 v[52:55], v[208:211], v[16:19], v[52:55]
    v_mfma_f32_16x16x32_bf16 v[52:55], v[212:215], v[20:23], v[52:55]
    s_nop 7
    v_cvt_pk_bf16_f32 v56, 0, v52
    v_cvt_pk_bf16_f32 v57, 0, v53
    v_cvt_pk_bf16_f32 v58, 0, v54
    v_cvt_pk_bf16_f32 v59, 0, v55
    v_mul_f32 v56, s5, v56
    v_mul_f32 v57, s5, v57
    v_mul_f32 v58, s5, v58
    v_mul_f32 v59, s5, v59
    v_cvt_pk_bf16_f32 v56, 0, v56
    v_cvt_pk_bf16_f32 v57, 0, v57
    v_cvt_pk_bf16_f32 v58, 0, v58
    v_cvt_pk_bf16_f32 v59, 0, v59
    v_max3_f32 v64, v56, v57, v58
    v_max_f32 v64, v64, v59
    v_mov_b32 v65, v64
    s_nop 1
    v_permlane32_swap_b32 v64, v65
    v_max_f32 v64, v64, v65
    v_mov_b32 v65, v64
    s_nop 1
    v_permlane16_swap_b32 v64, v65
    v_max_f32 v64, v64, v65
    v_mul_f32 v64, s4, v64
    v_max_f32 v68, v60, v64
    v_sub_f32 v62, v60, v68
    v_exp_f32 v62, v62
    v_fma_f32 v56, v56, s4, -v68
    v_fma_f32 v57, v57, s4, -v68
    v_fma_f32 v58, v58, s4, -v68
    v_fma_f32 v59, v59, s4, -v68
    v_mov_b32 v60, v68
    v_exp_f32 v56, v56
    v_exp_f32 v57, v57
    v_exp_f32 v58, v58
    v_exp_f32 v59, v59
    v_mov_b32_dpp v63, v62 row_newbcast:0 row_mask:0x1 bank_mask:0xf
    v_mov_b32_dpp v63, v62 row_newbcast:4 row_mask:0x2 bank_mask:0xf
    v_mov_b32_dpp v63, v62 row_newbcast:8 row_mask:0x4 bank_mask:0xf
    v_mov_b32_dpp v63, v62 row_newbcast:12 row_mask:0x8 bank_mask:0xf
    v_mul_f32 v61, v61, v62
    v_cvt_pk_bf16_f32 v64, v56, v56
    v_and_b32 v34, v64, v66
    v_and_b32 v35, v64, v67
    v_cvt_pk_bf16_f32 v64, v57, v57
    v_and_b32 v38, v64, v66
    v_and_b32 v39, v64, v67
    v_cvt_pk_bf16_f32 v64, v58, v58
    v_and_b32 v42, v64, v66
    v_and_b32 v43, v64, v67
    v_cvt_pk_bf16_f32 v64, v59, v59
    v_and_b32 v46, v64, v66
    v_and_b32 v47, v64, v67
    v_mul_f32 v24, v24, v63
    v_mul_f32 v25, v25, v63
    v_mul_f32 v26, v26, v63
    v_mul_f32 v27, v27, v63
    v_mul_f32 v28, v28, v63
    v_mul_f32 v29, v29, v63
    v_mul_f32 v30, v30, v63
    v_mul_f32 v31, v31, v63
    v_add_f32 v56, v56, v57
    v_add_f32 v58, v58, v59
    v_add_f32 v61, v61, v56
    v_add_f32 v61, v61, v58
    v_mfma_f32_16x16x32_bf16 v[24:27], v[34:37], v[216:219], v[24:27]
    v_mfma_f32_16x16x32_bf16 v[28:31], v[32:35], v[216:219], v[28:31]
    v_mfma_f32_16x16x32_bf16 v[24:27], v[38:41], v[220:223], v[24:27]
    v_mfma_f32_16x16x32_bf16 v[28:31], v[36:39], v[220:223], v[28:31]
    v_mfma_f32_16x16x32_bf16 v[24:27], v[42:45], v[224:227], v[24:27]
    v_mfma_f32_16x16x32_bf16 v[28:31], v[40:43], v[224:227], v[28:31]
    v_mfma_f32_16x16x32_bf16 v[24:27], v[46:49], v[228:231], v[24:27]
    v_mfma_f32_16x16x32_bf16 v[28:31], v[44:47], v[228:231], v[28:31]
    s_branch L_loop
L_slow0:
    s_sub_u32 s14, s14, s24
    s_lshr_b32 s12, s14, 13
    s_lshl_b32 s12, s12, 2
    v_mov_b32 v4, s12
    s_and_b32 s14, s14, 0x1fff
L_sp_25:
    ds_read_b32 v7, v4 offset:17680
    s_sub_u32 s75, s75, 1
    s_cbranch_scc1 L_exit
    s_waitcnt lgkmcnt(0)
    v_readfirstlane_b32 s12, v7
    s_cmp_eq_u32 s12, 0xfffffffe
    s_cbranch_scc1 L_sp_25
    s_add_u32 s14, s14, s12
    s_branch L_back0
L_slow1:
    s_sub_u32 s15, s15, s24
    s_lshr_b32 s12, s15, 13
    s_lshl_b32 s12, s12, 2
    v_mov_b32 v4, s12
    s_and_b32 s15, s15, 0x1fff
L_sp_26:
    ds_read_b32 v7, v4 offset:17680
    s_sub_u32 s75, s75, 1
    s_cbranch_scc1 L_exit
    s_waitcnt lgkmcnt(0)
    v_readfirstlane_b32 s12, v7
    s_cmp_eq_u32 s12, 0xfffffffe
    s_cbranch_scc1 L_sp_26
    s_add_u32 s15, s15, s12
    s_branch L_back1
L_epi:
    v_mov_b32 v65, v61
    s_nop 1
    v_permlane32_swap_b32 v61, v65
    v_add_f32 v61, v61, v65
    v_mov_b32 v65, v61
    s_nop 1
    v_permlane16_swap_b32 v61, v65
    v_add_f32 v61, v61, v65
    s_lshl_b32 s13, s3, 11
    v_lshlrev_b32 v4, 9, v2
    v_lshl_add_u32 v4, v3, 5, v4
    v_add_u32 v4, s13, v4
    ds_write_b128 v4, v[24:27] offset:1024
    ds_write_b128 v4, v[28:31] offset:1040
    v_lshrrev_b32 v4, 2, v3
    v_lshlrev_b32 v4, 5, v4
    s_lshl_b32 s13, s3, 2
    v_add_u32 v4, s13, v4
    ds_write_b32 v4, v60 offset:17408
    ds_write_b32 v4, v61 offset:17536
    v_mov_b32 v8, 1
    s_waitcnt lgkmcnt(0)
    s_mov_b64 exec, 1
    ds_add_u32 v70, v8 offset:12
    s_mov_b64 exec, -1
    s_cmp_lt_u32 s3, 2
    s_cbranch_scc1 L_comb
    s_cmp_lg_u32 s3, 7
    s_cbranch_scc1 L_epi2
    s_setprio 3
    s_and_b32 s13, s2, 15
L_agf:
    s_waitcnt vmcnt(0)
    v_cmp_ne_u32 vcc, s72, v244
    s_nop 0
    s_cmp_eq_u64 vcc, 0
    s_cbranch_scc1 L_ag0
    s_sub_u32 s75, s75, 1
    s_cbranch_scc1 L_exit
    s_lshl_b32 s12, s13, 2
    s_add_u32 s12, s12, 0x1000
    v_mov_b32 v4, 0
    buffer_load_dword v244, v4, s[52:55], s12 offen sc1
    s_branch L_agf
L_ag0:
    s_lshl_b32 s13, s13, 8
    s_add_u32 s13, s13, 0x18000
    s_sub_u32 s16, s24, 32768
    s_mov_b32 s17, 0
    s_and_b32 s12, s2, 12
    s_mov_b32 s30, 0x0
    s_cmp_eq_u32 s12, 12
    s_cmov_b32 s30, 0x0
    s_mov_b32 s31, 0x7c000
    v_mov_b32 v8, 0
    v_mov_b32 v9, 0x40000000
L_ag1:
    ds_read_b32 v7, v70
    s_sub_u32 s75, s75, 1
    s_cbranch_scc1 L_exit
    s_waitcnt lgkmcnt(0)
    v_readfirstlane_b32 s12, v7
    s_cmp_ge_u32 s12, s16
    s_cbranch_scc1 L_ag2
    s_sleep 3
    s_branch L_ag1
L_ag2:
    s_cmp_eq_u32 s73, 2
    s_cbranch_scc1 L_ag3
    s_sub_u32 s12, s12, s16
    s_lshr_b32 s12, s12, 13
    s_add_u32 s12, s12, 1
    s_min_u32 s12, s12, 16
    v_cmp_gt_u32 vcc, s12, v1
    v_mov_b32 v7, 0x2000
    v_add_u32 v4, s17, v1
    v_lshlrev_b32 v4, 2, v4
    s_mov_b64 exec, vcc
    buffer_atomic_add v7, v8, s[52:55], s13 offen sc0 sc1
    s_add_u32 s17, s17, s12
    s_lshl_b32 s12, s12, 13
    s_add_u32 s16, s16, s12
    s_waitcnt vmcnt(0)
    v_subrev_u32 v10, s30, v7
    v_lshrrev_b32 v11, 14, v10
    v_lshlrev_b32 v11, 19, v11
    v_and_b32 v10, 0x3fff, v10
    v_add3_u32 v10, v10, v11, s31
    v_add_u32 v11, 0x17c000, v7
    v_cmp_le_u32 vcc, s30, v7
    s_add_u32 s12, s30, 0x40000
    s_nop 0
    v_cndmask_b32 v11, v11, v10, vcc
    v_cmp_le_u32 vcc, s12, v7
    v_add_u32 v7, s25, v11
    v_and_b32 v7, 0x7fffff, v7
    v_cndmask_b32 v7, v7, v9, vcc
    ds_write_b32 v4, v7 offset:17680
    s_mov_b64 exec, -1
    s_cmp_eq_u64 vcc, 0
    s_cbranch_scc1 L_ag1
L_ag3:
    v_add_u32 v4, s17, v1
    v_lshlrev_b32 v4, 2, v4
    ds_write_b32 v4, v9 offset:17680
    ds_write_b32 v70, v9 offset:8
    s_setprio 0
L_epi2:
    s_cmp_lt_u32 s73, 2
    s_cbranch_scc1 L_role
    s_cmp_lt_u32 s3, 3
    s_cbranch_scc1 L_role
    s_sub_u32 s13, s24, 49152
    s_cmp_eq_u32 s73, 3
    s_cbranch_scc0 L_lww
    s_sub_u32 s13, s24, -409600
L_lww:
    ds_read_b96 v[8:10], v70
    s_sub_u32 s75, s75, 1
    s_cbranch_scc1 L_exit
    s_sleep 4
    s_waitcnt lgkmcnt(0)
    v_or_b32 v8, v8, v10
    s_nop 0
    v_readfirstlane_b32 s12, v8
    s_cmp_lt_u32 s12, s13
    s_cbranch_scc1 L_lww
    s_branch L_role
L_comb:
    s_lshl_b32 s12, s9, 5
    s_lshl_b32 s13, s8, 2
    s_add_u32 s12, s12, s13
    s_lshl_b32 s13, s12, 13
    s_lshl_b32 vcc_lo, s10, 9
    s_add_u32 s13, s13, vcc_lo
    s_add_u32 s13, s13, 0x80000
    s_lshl_b32 s12, s12, 7
    s_lshl_b32 vcc_lo, s10, 3
    s_add_u32 s12, s12, vcc_lo
    s_add_u32 s12, s12, 0xa000
L_cw:
    ds_read_b32 v8, v70 offset:12
    s_sub_u32 s75, s75, 1
    s_cbranch_scc1 L_exit
    s_waitcnt lgkmcnt(0)
    v_readfirstlane_b32 vcc_lo, v8
    s_cmp_lt_u32 vcc_lo, 8
    s_cbranch_scc1 L_cw
    v_bfe_u32 v7, v0, 5, 2
    v_lshlrev_b32 v4, 5, v7
    ds_read_b128 v[8:11], v4 offset:17408
    ds_read_b128 v[16:19], v4 offset:17536
    ds_read_b128 v[12:15], v4 offset:17424
    ds_read_b128 v[20:23], v4 offset:17552
    v_and_b32 v4, 127, v0
    v_lshlrev_b32 v4, 4, v4
    ds_read_b128 v[24:27], v4 offset:1024
    ds_read_b128 v[28:31], v4 offset:3072
    ds_read_b128 v[32:35], v4 offset:5120
    ds_read_b128 v[36:39], v4 offset:7168
    ds_read_b128 v[40:43], v4 offset:9216
    ds_read_b128 v[44:47], v4 offset:11264
    ds_read_b128 v[48:51], v4 offset:13312
    ds_read_b128 v[52:55], v4 offset:15360
    s_waitcnt lgkmcnt(8)
    v_max_f32 v60, v8, v9
    v_max3_f32 v60, v60, v10, v11
    v_max3_f32 v60, v60, v12, v13
    v_max3_f32 v60, v60, v14, v15
    v_sub_f32 v8, v8, v60
    v_sub_f32 v9, v9, v60
    v_sub_f32 v10, v10, v60
    v_sub_f32 v11, v11, v60
    v_sub_f32 v12, v12, v60
    v_sub_f32 v13, v13, v60
    v_sub_f32 v14, v14, v60
    v_sub_f32 v15, v15, v60
    v_exp_f32 v8, v8
    v_exp_f32 v9, v9
    v_exp_f32 v10, v10
    v_exp_f32 v11, v11
    v_exp_f32 v12, v12
    v_exp_f32 v13, v13
    v_exp_f32 v14, v14
    v_exp_f32 v15, v15
    v_lshlrev_b32 v4, 13, v7
    v_mul_f32 v61, v8, v16
    v_fmac_f32 v61, v9, v17
    v_fmac_f32 v61, v10, v18
    v_fmac_f32 v61, v11, v19
    v_fmac_f32 v61, v12, v20
    v_fmac_f32 v61, v13, v21
    v_fmac_f32 v61, v14, v22
    v_fmac_f32 v61, v15, v23
    v_and_b32 v62, 31, v0
    v_lshl_add_u32 v4, v62, 4, v4
    s_waitcnt lgkmcnt(7)
    v_mul_f32 v56, v8, v24
    v_mul_f32 v57, v8, v25
    v_mul_f32 v58, v8, v26
    v_mul_f32 v59, v8, v27
    s_waitcnt lgkmcnt(6)
    v_fmac_f32 v56, v9, v28
    v_fmac_f32 v57, v9, v29
    v_fmac_f32 v58, v9, v30
    v_fmac_f32 v59, v9, v31
    s_waitcnt lgkmcnt(5)
    v_fmac_f32 v56, v10, v32
    v_fmac_f32 v57, v10, v33
    v_fmac_f32 v58, v10, v34
    v_fmac_f32 v59, v10, v35
    s_waitcnt lgkmcnt(4)
    v_fmac_f32 v56, v11, v36
    v_fmac_f32 v57, v11, v37
    v_fmac_f32 v58, v11, v38
    v_fmac_f32 v59, v11, v39
    s_waitcnt lgkmcnt(3)
    v_fmac_f32 v56, v12, v40
    v_fmac_f32 v57, v12, v41
    v_fmac_f32 v58, v12, v42
    v_fmac_f32 v59, v12, v43
    s_waitcnt lgkmcnt(2)
    v_fmac_f32 v56, v13, v44
    v_fmac_f32 v57, v13, v45
    v_fmac_f32 v58, v13, v46
    v_fmac_f32 v59, v13, v47
    s_waitcnt lgkmcnt(1)
    v_fmac_f32 v56, v14, v48
    v_fmac_f32 v57, v14, v49
    v_fmac_f32 v58, v14, v50
    v_fmac_f32 v59, v14, v51
    s_waitcnt lgkmcnt(0)
    v_fmac_f32 v56, v15, v52
    v_fmac_f32 v57, v15, v53
    v_fmac_f32 v58, v15, v54
    v_fmac_f32 v59, v15, v55
    v_min_u32 v56, -2, v56
    v_min_u32 v57, -2, v57
    v_min_u32 v58, -2, v58
    v_min_u32 v59, -2, v59
    v_min_u32 v60, -2, v60
    v_min_u32 v61, -2, v61
    buffer_store_dwordx4 v[56:59], v4, s[52:55], s13 offen offset:0 sc1
    v_lshlrev_b32 v4, 7, v7
    buffer_store_dwordx2 v[60:61], v4, s[52:55], s12 offen offset:0 sc1
L_role:
    s_cmp_eq_u32 s73, 0
    s_cbranch_scc1 L_done
    s_cmp_lt_u32 s73, 2
    s_cbranch_scc1 L_nolw2
    s_cmp_eq_u32 s73, 3
    s_cbranch_scc1 L_ffn_w_27
    s_lshl_b32 s13, s8, 19
    s_lshl_b32 s12, s3, 16
    s_add_u32 s13, s13, s12
    s_lshl_b32 s12, s76, 8
    s_add_u32 s13, s13, s12
    v_lshlrev_b32 v4, 14, v2
    v_lshl_add_u32 v4, v3, 4, v4
    buffer_load_dwordx4 v[136:139], v4, s[48:51], s13 offen offset:0 nt
    buffer_load_dwordx4 v[140:143], v4, s[48:51], s13 offen offset:1024 nt
    buffer_load_dwordx4 v[144:147], v4, s[48:51], s13 offen offset:2048 nt
    buffer_load_dwordx4 v[148:151], v4, s[48:51], s13 offen offset:3072 nt
    s_add_u32 s13, s13, 4096
    buffer_load_dwordx4 v[152:155], v4, s[48:51], s13 offen offset:0 nt
    buffer_load_dwordx4 v[156:159], v4, s[48:51], s13 offen offset:1024 nt
    buffer_load_dwordx4 v[160:163], v4, s[48:51], s13 offen offset:2048 nt
    buffer_load_dwordx4 v[164:167], v4, s[48:51], s13 offen offset:3072 nt
    s_add_u32 s13, s13, 4096
    buffer_load_dwordx4 v[168:171], v4, s[48:51], s13 offen offset:0 nt
    buffer_load_dwordx4 v[172:175], v4, s[48:51], s13 offen offset:1024 nt
    buffer_load_dwordx4 v[176:179], v4, s[48:51], s13 offen offset:2048 nt
    buffer_load_dwordx4 v[180:183], v4, s[48:51], s13 offen offset:3072 nt
    s_add_u32 s13, s13, 4096
    buffer_load_dwordx4 v[184:187], v4, s[48:51], s13 offen offset:0 nt
    buffer_load_dwordx4 v[188:191], v4, s[48:51], s13 offen offset:1024 nt
    buffer_load_dwordx4 v[192:195], v4, s[48:51], s13 offen offset:2048 nt
    buffer_load_dwordx4 v[196:199], v4, s[48:51], s13 offen offset:3072 nt
    s_add_u32 s13, s13, 4096
    s_branch L_sels_27
L_ffn_w_27:
    s_mul_i32 s13, s3, 64*3584
    s_lshl_b32 s12, s76, 6
    s_add_u32 s13, s13, s12
    s_mov_b32 s12, 16*3584
    v_mul_lo_u32 v4, v2, s12
    v_and_b32 v7, 3, v3
    v_lshl_add_u32 v4, v7, 4, v4
    s_mov_b32 s12, s13
    s_mov_b32 exec_lo, 0x000f000f
    s_mov_b32 exec_hi, 0x000f000f
    buffer_load_dwordx4 v[136:139], v4, s[48:51], s13 offen nt
    s_add_u32 s13, s13, 3584
    buffer_load_dwordx4 v[140:143], v4, s[48:51], s13 offen nt
    s_add_u32 s13, s13, 3584
    buffer_load_dwordx4 v[144:147], v4, s[48:51], s13 offen nt
    s_add_u32 s13, s13, 3584
    buffer_load_dwordx4 v[148:151], v4, s[48:51], s13 offen nt
    s_add_u32 s13, s13, 3584
    buffer_load_dwordx4 v[152:155], v4, s[48:51], s13 offen nt
    s_add_u32 s13, s13, 3584
    buffer_load_dwordx4 v[156:159], v4, s[48:51], s13 offen nt
    s_add_u32 s13, s13, 3584
    buffer_load_dwordx4 v[160:163], v4, s[48:51], s13 offen nt
    s_add_u32 s13, s13, 3584
    buffer_load_dwordx4 v[164:167], v4, s[48:51], s13 offen nt
    s_add_u32 s13, s13, 3584
    buffer_load_dwordx4 v[168:171], v4, s[48:51], s13 offen nt
    s_add_u32 s13, s13, 3584
    buffer_load_dwordx4 v[172:175], v4, s[48:51], s13 offen nt
    s_add_u32 s13, s13, 3584
    buffer_load_dwordx4 v[176:179], v4, s[48:51], s13 offen nt
    s_add_u32 s13, s13, 3584
    buffer_load_dwordx4 v[180:183], v4, s[48:51], s13 offen nt
    s_add_u32 s13, s13, 3584
    buffer_load_dwordx4 v[184:187], v4, s[48:51], s13 offen nt
    s_add_u32 s13, s13, 3584
    buffer_load_dwordx4 v[188:191], v4, s[48:51], s13 offen nt
    s_add_u32 s13, s13, 3584
    buffer_load_dwordx4 v[192:195], v4, s[48:51], s13 offen nt
    s_add_u32 s13, s13, 3584
    buffer_load_dwordx4 v[196:199], v4, s[48:51], s13 offen nt
    s_add_u32 s13, s13, 3584
    s_mov_b32 exec_lo, 0x00f000f0
    s_mov_b32 exec_hi, 0x00f000f0
    buffer_load_dwordx4 v[136:139], v4, s[56:59], s12 offen nt
    s_add_u32 s12, s12, 3584
    buffer_load_dwordx4 v[140:143], v4, s[56:59], s12 offen nt
    s_add_u32 s12, s12, 3584
    buffer_load_dwordx4 v[144:147], v4, s[56:59], s12 offen nt
    s_add_u32 s12, s12, 3584
    buffer_load_dwordx4 v[148:151], v4, s[56:59], s12 offen nt
    s_add_u32 s12, s12, 3584
    buffer_load_dwordx4 v[152:155], v4, s[56:59], s12 offen nt
    s_add_u32 s12, s12, 3584
    buffer_load_dwordx4 v[156:159], v4, s[56:59], s12 offen nt
    s_add_u32 s12, s12, 3584
    buffer_load_dwordx4 v[160:163], v4, s[56:59], s12 offen nt
    s_add_u32 s12, s12, 3584
    buffer_load_dwordx4 v[164:167], v4, s[56:59], s12 offen nt
    s_add_u32 s12, s12, 3584
    buffer_load_dwordx4 v[168:171], v4, s[56:59], s12 offen nt
    s_add_u32 s12, s12, 3584
    buffer_load_dwordx4 v[172:175], v4, s[56:59], s12 offen nt
    s_add_u32 s12, s12, 3584
    buffer_load_dwordx4 v[176:179], v4, s[56:59], s12 offen nt
    s_add_u32 s12, s12, 3584
    buffer_load_dwordx4 v[180:183], v4, s[56:59], s12 offen nt
    s_add_u32 s12, s12, 3584
    buffer_load_dwordx4 v[184:187], v4, s[56:59], s12 offen nt
    s_add_u32 s12, s12, 3584
    buffer_load_dwordx4 v[188:191], v4, s[56:59], s12 offen nt
    s_add_u32 s12, s12, 3584
    buffer_load_dwordx4 v[192:195], v4, s[56:59], s12 offen nt
    s_add_u32 s12, s12, 3584
    buffer_load_dwordx4 v[196:199], v4, s[56:59], s12 offen nt
    s_add_u32 s12, s12, 3584
    s_mov_b64 exec, -1
    s_cmp_lt_u32 s3, 4
    s_cbranch_scc1 L_sels_27
    s_lshl_b32 s13, s76, 15
    s_and_b32 s12, s3, 3
    s_lshl_b32 s12, s12, 8
    s_add_u32 s13, s13, s12
    v_lshlrev_b32 v4, 13, v2
    v_lshl_add_u32 v4, v3, 4, v4
    buffer_load_dwordx4 v[200:203], v4, s[60:63], s13 offen offset:0 nt
    buffer_load_dwordx4 v[204:207], v4, s[60:63], s13 offen offset:1024 nt
    buffer_load_dwordx4 v[208:211], v4, s[60:63], s13 offen offset:2048 nt
    buffer_load_dwordx4 v[212:215], v4, s[60:63], s13 offen offset:3072 nt
    s_add_u32 s13, s13, 4096
    buffer_load_dwordx4 v[216:219], v4, s[60:63], s13 offen offset:0 nt
    buffer_load_dwordx4 v[220:223], v4, s[60:63], s13 offen offset:1024 nt
    buffer_load_dwordx4 v[224:227], v4, s[60:63], s13 offen offset:2048 nt
    buffer_load_dwordx4 v[228:231], v4, s[60:63], s13 offen offset:3072 nt
    s_add_u32 s13, s13, 4096
L_sels_27:
    v_and_b32 v8, 1, v3
    v_cmp_eq_u32 vcc, 1, v8
    v_mov_b32 v8, 0xc0c0100
    v_mov_b32 v9, 0x1000c0c
    v_cndmask_b32 v9, v8, v9, vcc
    v_bfe_u32 v8, v3, 1, 2
    v_cmp_eq_u32 vcc, 0, v8
    v_mov_b32 v232, 0x0c0c0c0c
    s_nop 0
    v_cndmask_b32 v232, v232, v9, vcc
    v_cmp_eq_u32 vcc, 1, v8
    v_mov_b32 v233, 0x0c0c0c0c
    s_nop 0
    v_cndmask_b32 v233, v233, v9, vcc
    v_cmp_eq_u32 vcc, 2, v8
    v_mov_b32 v234, 0x0c0c0c0c
    s_nop 0
    v_cndmask_b32 v234, v234, v9, vcc
    v_cmp_eq_u32 vcc, 3, v8
    v_mov_b32 v235, 0x0c0c0c0c
    s_nop 0
    v_cndmask_b32 v235, v235, v9, vcc
    v_and_b32 v8, 1, v3
    v_cmp_eq_u32 vcc, 1, v8
    v_mov_b32 v8, 0xc0c0302
    v_mov_b32 v9, 0x3020c0c
    v_cndmask_b32 v9, v8, v9, vcc
    v_bfe_u32 v8, v3, 1, 2
    v_cmp_eq_u32 vcc, 0, v8
    v_mov_b32 v236, 0x0c0c0c0c
    s_nop 0
    v_cndmask_b32 v236, v236, v9, vcc
    v_cmp_eq_u32 vcc, 1, v8
    v_mov_b32 v237, 0x0c0c0c0c
    s_nop 0
    v_cndmask_b32 v237, v237, v9, vcc
    v_cmp_eq_u32 vcc, 2, v8
    v_mov_b32 v238, 0x0c0c0c0c
    s_nop 0
    v_cndmask_b32 v238, v238, v9, vcc
    v_cmp_eq_u32 vcc, 3, v8
    v_mov_b32 v239, 0x0c0c0c0c
    s_nop 0
    v_cndmask_b32 v239, v239, v9, vcc
L_nolw2:
    v_xor_b32 v8, s72, v240
    v_xor_b32 v9, s72, v241
    v_or_b32 v8, v8, v9
    v_xor_b32 v9, s72, v242
    v_or_b32 v8, v8, v9
    v_xor_b32 v9, s72, v243
    v_or_b32 v8, v8, v9
    v_cmp_ne_u32 vcc, 0, v8
    s_nop 0
    s_cmp_eq_u64 vcc, 0
    s_cbranch_scc1 L_flok_28
    v_lshlrev_b32 v4, 4, v1
    s_mov_b32 s13, 0x1000
    s_mov_b64 s[78:79], -1
L_poll_30:
    s_mov_b64 exec, s[78:79]
    s_cbranch_execz L_psk_31
    buffer_load_dwordx4 v[240:243], v4, s[52:55], s13 offen offset:0 sc1
L_psk_31:
    s_mov_b64 exec, -1
    s_waitcnt vmcnt(0)
    v_xor_b32 v8, s72, v240
    v_xor_b32 v9, s72, v241
    v_or_b32 v8, v8, v9
    v_xor_b32 v9, s72, v242
    v_or_b32 v8, v8, v9
    v_xor_b32 v9, s72, v243
    v_or_b32 v8, v8, v9
    v_cmp_ne_u32 s[78:79], 0, v8
    s_nop 0
    s_mov_b64 vcc, s[78:79]
    s_cmp_eq_u64 vcc, 0
    s_cbranch_scc1 L_pdone_29
    s_sub_u32 s75, s75, 1
    s_cbranch_scc1 L_exit
    s_sleep 8
    s_branch L_poll_30
L_pdone_29:
L_flok_28:
    s_cmp_eq_u32 s73, 3
    s_cbranch_scc1 L_ffn
    s_cmp_eq_u32 s73, 1
    s_cbranch_scc1 L_fin
    s_lshr_b32 s12, s3, 2
    s_lshl_b32 s12, s12, 5
    s_lshl_b32 s13, s8, 2
    s_add_u32 s12, s12, s13
    s_and_b32 s13, s3, 3
    s_add_u32 s12, s12, s13
    s_lshl_b32 vcc_hi, s12, 7
    s_add_u32 s11, vcc_hi, 0xa000
    s_lshl_b32 s13, s12, 13
    s_add_u32 s13, s13, 0x80000
    v_lshl_add_u32 v4, v2, 2, v3
    v_and_b32 v4, 15, v4
    v_lshlrev_b32 v4, 3, v4
    v_lshlrev_b32 v7, 11, v2
    v_lshl_add_u32 v7, v3, 4, v7
    s_barrier
L_gate_33:
    buffer_load_dwordx2 v[104:105], v4, s[52:55], s11 offen sc1
    s_waitcnt vmcnt(0)
    v_cmp_eq_u32 vcc, -1, v104
    s_nop 0
    s_bcnt1_i32_b64 s12, vcc
    s_cmp_le_u32 s12, 16
    s_cbranch_scc1 L_gdone_32
    s_sub_u32 s75, s75, 1
    s_cbranch_scc1 L_exit
    s_sleep 8
    s_branch L_gate_33
L_gdone_32:
    s_mov_b64 s[78:79], -1
    s_mov_b64 s[80:81], -1
    s_mov_b64 s[82:83], -1
    s_mov_b64 s[84:85], -1
    s_mov_b64 s[86:87], -1
L_poll_35:
    s_mov_b64 exec, s[78:79]
    s_cbranch_execz L_psk_36
    buffer_load_dwordx4 v[72:75], v7, s[52:55], s13 offen offset:0 sc1
    buffer_load_dwordx4 v[76:79], v7, s[52:55], s13 offen offset:256 sc1
L_psk_36:
    s_mov_b64 exec, s[80:81]
    s_cbranch_execz L_psk_37
    buffer_load_dwordx4 v[80:83], v7, s[52:55], s13 offen offset:512 sc1
    buffer_load_dwordx4 v[84:87], v7, s[52:55], s13 offen offset:768 sc1
L_psk_37:
    s_mov_b64 exec, s[82:83]
    s_cbranch_execz L_psk_38
    buffer_load_dwordx4 v[88:91], v7, s[52:55], s13 offen offset:1024 sc1
    buffer_load_dwordx4 v[92:95], v7, s[52:55], s13 offen offset:1280 sc1
L_psk_38:
    s_mov_b64 exec, s[84:85]
    s_cbranch_execz L_psk_39
    buffer_load_dwordx4 v[96:99], v7, s[52:55], s13 offen offset:1536 sc1
    buffer_load_dwordx4 v[100:103], v7, s[52:55], s13 offen offset:1792 sc1
L_psk_39:
    s_mov_b64 exec, s[86:87]
    s_cbranch_execz L_psk_40
    buffer_load_dwordx2 v[104:105], v4, s[52:55], s11 offen offset:0 sc1
L_psk_40:
    s_mov_b64 exec, -1
    s_waitcnt vmcnt(0)
    v_max_u32 v8, v72, v73
    v_max3_u32 v8, v8, v74, v75
    v_max3_u32 v8, v8, v76, v77
    v_max3_u32 v8, v8, v78, v79
    v_cmp_eq_u32 s[78:79], -1, v8
    v_max_u32 v8, v80, v81
    v_max3_u32 v8, v8, v82, v83
    v_max3_u32 v8, v8, v84, v85
    v_max3_u32 v8, v8, v86, v87
    v_cmp_eq_u32 s[80:81], -1, v8
    v_max_u32 v8, v88, v89
    v_max3_u32 v8, v8, v90, v91
    v_max3_u32 v8, v8, v92, v93
    v_max3_u32 v8, v8, v94, v95
    v_cmp_eq_u32 s[82:83], -1, v8
    v_max_u32 v8, v96, v97
    v_max3_u32 v8, v8, v98, v99
    v_max3_u32 v8, v8, v100, v101
    v_max3_u32 v8, v8, v102, v103
    v_cmp_eq_u32 s[84:85], -1, v8
    v_max_u32 v8, v104, v105
    v_cmp_eq_u32 s[86:87], -1, v8
    s_nop 0
    s_mov_b64 vcc, s[78:79]
    s_or_b64 vcc, vcc, s[80:81]
    s_or_b64 vcc, vcc, s[82:83]
    s_or_b64 vcc, vcc, s[84:85]
    s_or_b64 vcc, vcc, s[86:87]
    s_cmp_eq_u64 vcc, 0
    s_cbranch_scc1 L_pdone_34
    s_sub_u32 s75, s75, 1
    s_cbranch_scc1 L_exit
    s_branch L_poll_35
L_pdone_34:
    v_mov_b32 v50, v104
    s_nop 1
    v_max_f32_dpp v50, v50, v50 quad_perm:[1,0,3,2] row_mask:0xf bank_mask:0xf
    s_nop 1
    v_max_f32_dpp v50, v50, v50 quad_perm:[2,3,0,1] row_mask:0xf bank_mask:0xf
    s_nop 1
    v_max_f32_dpp v50, v50, v50 row_half_mirror row_mask:0xf bank_mask:0xf
    s_nop 1
    v_max_f32_dpp v50, v50, v50 row_mirror row_mask:0xf bank_mask:0xf
    v_sub_f32 v50, v104, v50
    v_exp_f32 v50, v50
    s_nop 0
    v_mul_f32 v51, v50, v105
    s_nop 1
    v_add_f32_dpp v51, v51, v51 quad_perm:[1,0,3,2] row_mask:0xf bank_mask:0xf
    s_nop 1
    v_add_f32_dpp v51, v51, v51 quad_perm:[2,3,0,1] row_mask:0xf bank_mask:0xf
    s_nop 1
    v_add_f32_dpp v51, v51, v51 row_half_mirror row_mask:0xf bank_mask:0xf
    s_nop 1
    v_add_f32_dpp v51, v51, v51 row_mirror row_mask:0xf bank_mask:0xf
    v_rcp_f32 v52, v51
    s_nop 0
    v_fma_f32 v53, -v51, v52, 1.0
    v_fmac_f32 v52, v53, v52
    v_mul_f32 v50, v50, v52
    v_lshrrev_b32 v4, 1, v2
    v_lshlrev_b32 v4, 7, v4
    v_mul_f32_dpp v32, v50, v72 row_newbcast:0 row_mask:0xf bank_mask:0xf
    v_mul_f32_dpp v33, v50, v73 row_newbcast:0 row_mask:0xf bank_mask:0xf
    v_mul_f32_dpp v34, v50, v74 row_newbcast:0 row_mask:0xf bank_mask:0xf
    v_mul_f32_dpp v35, v50, v75 row_newbcast:0 row_mask:0xf bank_mask:0xf
    v_mul_f32_dpp v36, v50, v76 row_newbcast:0 row_mask:0xf bank_mask:0xf
    v_mul_f32_dpp v37, v50, v77 row_newbcast:0 row_mask:0xf bank_mask:0xf
    v_mul_f32_dpp v38, v50, v78 row_newbcast:0 row_mask:0xf bank_mask:0xf
    v_mul_f32_dpp v39, v50, v79 row_newbcast:0 row_mask:0xf bank_mask:0xf
    v_fmac_f32_dpp v32, v50, v80 row_newbcast:1 row_mask:0xf bank_mask:0xf
    v_fmac_f32_dpp v33, v50, v81 row_newbcast:1 row_mask:0xf bank_mask:0xf
    v_fmac_f32_dpp v34, v50, v82 row_newbcast:1 row_mask:0xf bank_mask:0xf
    v_fmac_f32_dpp v35, v50, v83 row_newbcast:1 row_mask:0xf bank_mask:0xf
    v_fmac_f32_dpp v36, v50, v84 row_newbcast:1 row_mask:0xf bank_mask:0xf
    v_fmac_f32_dpp v37, v50, v85 row_newbcast:1 row_mask:0xf bank_mask:0xf
    v_fmac_f32_dpp v38, v50, v86 row_newbcast:1 row_mask:0xf bank_mask:0xf
    v_fmac_f32_dpp v39, v50, v87 row_newbcast:1 row_mask:0xf bank_mask:0xf
    v_fmac_f32_dpp v32, v50, v88 row_newbcast:2 row_mask:0xf bank_mask:0xf
    v_fmac_f32_dpp v33, v50, v89 row_newbcast:2 row_mask:0xf bank_mask:0xf
    v_fmac_f32_dpp v34, v50, v90 row_newbcast:2 row_mask:0xf bank_mask:0xf
    v_fmac_f32_dpp v35, v50, v91 row_newbcast:2 row_mask:0xf bank_mask:0xf
    v_fmac_f32_dpp v36, v50, v92 row_newbcast:2 row_mask:0xf bank_mask:0xf
    v_fmac_f32_dpp v37, v50, v93 row_newbcast:2 row_mask:0xf bank_mask:0xf
    v_fmac_f32_dpp v38, v50, v94 row_newbcast:2 row_mask:0xf bank_mask:0xf
    v_fmac_f32_dpp v39, v50, v95 row_newbcast:2 row_mask:0xf bank_mask:0xf
    v_fmac_f32_dpp v32, v50, v96 row_newbcast:3 row_mask:0xf bank_mask:0xf
    v_fmac_f32_dpp v33, v50, v97 row_newbcast:3 row_mask:0xf bank_mask:0xf
    v_fmac_f32_dpp v34, v50, v98 row_newbcast:3 row_mask:0xf bank_mask:0xf
    v_fmac_f32_dpp v35, v50, v99 row_newbcast:3 row_mask:0xf bank_mask:0xf
    v_fmac_f32_dpp v36, v50, v100 row_newbcast:3 row_mask:0xf bank_mask:0xf
    v_fmac_f32_dpp v37, v50, v101 row_newbcast:3 row_mask:0xf bank_mask:0xf
    v_fmac_f32_dpp v38, v50, v102 row_newbcast:3 row_mask:0xf bank_mask:0xf
    v_fmac_f32_dpp v39, v50, v103 row_newbcast:3 row_mask:0xf bank_mask:0xf
    v_lshl_add_u32 v4, v3, 3, v4
    v_and_b32 v7, 1, v2
    v_permlane32_swap_b32 v32, v36
    v_permlane32_swap_b32 v33, v37
    v_permlane32_swap_b32 v34, v38
    v_permlane32_swap_b32 v35, v39
    v_add_f32 v32, v32, v36
    v_add_f32 v33, v33, v37
    v_add_f32 v34, v34, v38
    v_add_f32 v35, v35, v39
    v_lshl_add_u32 v4, v7, 2, v4
    s_lshl_b32 s13, s3, 8
    v_permlane16_swap_b32 v32, v34
    v_permlane16_swap_b32 v33, v35
    v_add_f32 v32, v32, v34
    v_add_f32 v33, v33, v35
    v_add_u32 v4, s13, v4
    v_cvt_pk_bf16_f32 v32, v32, v33
    ds_write_b32 v4, v32 offset:1024
    v_lshrrev_b32 v4, 3, v3
    v_lshlrev_b32 v4, 10, v4
    v_lshl_add_u32 v4, v2, 5, v4
    s_lshl_b32 s13, s3, 7
    v_add_u32 v4, s13, v4
    s_waitcnt lgkmcnt(0)
    s_barrier
    ds_read_b128 v[16:19], v4 offset:1024
    ds_read_b128 v[20:23], v4 offset:1040
    s_waitcnt lgkmcnt(0)
    v_perm_b32 v52, v16, v16, v232
    v_perm_b32 v53, v16, v16, v233
    v_perm_b32 v54, v16, v16, v234
    v_perm_b32 v55, v16, v16, v235
    v_perm_b32 v56, v16, v16, v236
    v_perm_b32 v57, v16, v16, v237
    v_perm_b32 v58, v16, v16, v238
    v_perm_b32 v59, v16, v16, v239
    v_mfma_f32_16x16x32_bf16 v[60:63], v[52:55], v[136:139], 0
    v_perm_b32 v52, v17, v17, v232
    v_perm_b32 v53, v17, v17, v233
    v_perm_b32 v54, v17, v17, v234
    v_perm_b32 v55, v17, v17, v235
    v_mfma_f32_16x16x32_bf16 v[60:63], v[56:59], v[140:143], v[60:63]
    v_perm_b32 v56, v17, v17, v236
    v_perm_b32 v57, v17, v17, v237
    v_perm_b32 v58, v17, v17, v238
    v_perm_b32 v59, v17, v17, v239
    v_mfma_f32_16x16x32_bf16 v[60:63], v[52:55], v[144:147], v[60:63]
    v_perm_b32 v52, v18, v18, v232
    v_perm_b32 v53, v18, v18, v233
    v_perm_b32 v54, v18, v18, v234
    v_perm_b32 v55, v18, v18, v235
    v_mfma_f32_16x16x32_bf16 v[60:63], v[56:59], v[148:151], v[60:63]
    v_perm_b32 v56, v18, v18, v236
    v_perm_b32 v57, v18, v18, v237
    v_perm_b32 v58, v18, v18, v238
    v_perm_b32 v59, v18, v18, v239
    v_mfma_f32_16x16x32_bf16 v[60:63], v[52:55], v[152:155], v[60:63]
    v_perm_b32 v52, v19, v19, v232
    v_perm_b32 v53, v19, v19, v233
    v_perm_b32 v54, v19, v19, v234
    v_perm_b32 v55, v19, v19, v235
    v_mfma_f32_16x16x32_bf16 v[60:63], v[56:59], v[156:159], v[60:63]
    v_perm_b32 v56, v19, v19, v236
    v_perm_b32 v57, v19, v19, v237
    v_perm_b32 v58, v19, v19, v238
    v_perm_b32 v59, v19, v19, v239
    v_mfma_f32_16x16x32_bf16 v[60:63], v[52:55], v[160:163], v[60:63]
    v_perm_b32 v52, v20, v20, v232
    v_perm_b32 v53, v20, v20, v233
    v_perm_b32 v54, v20, v20, v234
    v_perm_b32 v55, v20, v20, v235
    v_mfma_f32_16x16x32_bf16 v[60:63], v[56:59], v[164:167], v[60:63]
    v_perm_b32 v56, v20, v20, v236
    v_perm_b32 v57, v20, v20, v237
    v_perm_b32 v58, v20, v20, v238
    v_perm_b32 v59, v20, v20, v239
    v_mfma_f32_16x16x32_bf16 v[60:63], v[52:55], v[168:171], v[60:63]
    v_perm_b32 v52, v21, v21, v232
    v_perm_b32 v53, v21, v21, v233
    v_perm_b32 v54, v21, v21, v234
    v_perm_b32 v55, v21, v21, v235
    v_mfma_f32_16x16x32_bf16 v[60:63], v[56:59], v[172:175], v[60:63]
    v_perm_b32 v56, v21, v21, v236
    v_perm_b32 v57, v21, v21, v237
    v_perm_b32 v58, v21, v21, v238
    v_perm_b32 v59, v21, v21, v239
    v_mfma_f32_16x16x32_bf16 v[60:63], v[52:55], v[176:179], v[60:63]
    v_perm_b32 v52, v22, v22, v232
    v_perm_b32 v53, v22, v22, v233
    v_perm_b32 v54, v22, v22, v234
    v_perm_b32 v55, v22, v22, v235
    v_mfma_f32_16x16x32_bf16 v[60:63], v[56:59], v[180:183], v[60:63]
    v_perm_b32 v56, v22, v22, v236
    v_perm_b32 v57, v22, v22, v237
    v_perm_b32 v58, v22, v22, v238
    v_perm_b32 v59, v22, v22, v239
    v_mfma_f32_16x16x32_bf16 v[60:63], v[52:55], v[184:187], v[60:63]
    v_perm_b32 v52, v23, v23, v232
    v_perm_b32 v53, v23, v23, v233
    v_perm_b32 v54, v23, v23, v234
    v_perm_b32 v55, v23, v23, v235
    v_mfma_f32_16x16x32_bf16 v[60:63], v[56:59], v[188:191], v[60:63]
    v_perm_b32 v56, v23, v23, v236
    v_perm_b32 v57, v23, v23, v237
    v_perm_b32 v58, v23, v23, v238
    v_perm_b32 v59, v23, v23, v239
    v_mfma_f32_16x16x32_bf16 v[60:63], v[52:55], v[192:195], v[60:63]
    s_nop 1
    v_mfma_f32_16x16x32_bf16 v[60:63], v[56:59], v[196:199], v[60:63]
    v_lshlrev_b32 v4, 4, v0
    s_nop 7
    ds_write_b128 v4, v[60:63] offset:3072
    s_waitcnt lgkmcnt(0)
    s_barrier
    s_cmp_ge_u32 s3, 1
    s_cbranch_scc1 L_done
    v_lshlrev_b32 v4, 4, v1
    ds_read_b128 v[8:11], v4 offset:3072
    ds_read_b128 v[12:15], v4 offset:4096
    ds_read_b128 v[16:19], v4 offset:5120
    ds_read_b128 v[20:23], v4 offset:6144
    ds_read_b128 v[24:27], v4 offset:7168
    ds_read_b128 v[28:31], v4 offset:8192
    ds_read_b128 v[32:35], v4 offset:9216
    ds_read_b128 v[36:39], v4 offset:10240
    s_waitcnt lgkmcnt(6)
    v_add_f32 v8, v8, v12
    v_add_f32 v9, v9, v13
    v_add_f32 v10, v10, v14
    v_add_f32 v11, v11, v15
    s_waitcnt lgkmcnt(5)
    v_add_f32 v8, v8, v16
    v_add_f32 v9, v9, v17
    v_add_f32 v10, v10, v18
    v_add_f32 v11, v11, v19
    s_waitcnt lgkmcnt(4)
    v_add_f32 v8, v8, v20
    v_add_f32 v9, v9, v21
    v_add_f32 v10, v10, v22
    v_add_f32 v11, v11, v23
    s_waitcnt lgkmcnt(3)
    v_add_f32 v8, v8, v24
    v_add_f32 v9, v9, v25
    v_add_f32 v10, v10, v26
    v_add_f32 v11, v11, v27
    s_waitcnt lgkmcnt(2)
    v_add_f32 v8, v8, v28
    v_add_f32 v9, v9, v29
    v_add_f32 v10, v10, v30
    v_add_f32 v11, v11, v31
    s_waitcnt lgkmcnt(1)
    v_add_f32 v8, v8, v32
    v_add_f32 v9, v9, v33
    v_add_f32 v10, v10, v34
    v_add_f32 v11, v11, v35
    s_waitcnt lgkmcnt(0)
    v_add_f32 v8, v8, v36
    v_add_f32 v9, v9, v37
    v_add_f32 v10, v10, v38
    v_add_f32 v11, v11, v39
    v_min_u32 v8, -2, v8
    v_min_u32 v9, -2, v9
    v_min_u32 v10, -2, v10
    v_min_u32 v11, -2, v11
    v_lshrrev_b32 v4, 1, v2
    v_lshlrev_b32 v4, 11, v4
    v_lshl_add_u32 v4, v3, 5, v4
    v_and_b32 v7, 1, v2
    v_lshl_add_u32 v4, v7, 4, v4
    s_lshl_b32 s13, s8, 12
    s_lshl_b32 s12, s76, 9
    s_add_u32 s13, s13, s12
    s_add_u32 s13, s13, 0xc000
    buffer_store_dwordx4 v[8:11], v4, s[52:55], s13 offen offset:0 sc1
    s_branch L_done
L_ffn:
    v_lshlrev_b32 v4, 3, v0
    v_lshlrev_b32 v7, 2, v0
    buffer_load_dword v88, v7, s[64:67], 0 offen
L_nx_41:
    s_mov_b32 s13, 0xc000
    s_mov_b32 s11, 0x10000
    s_barrier
    v_and_b32 v8, 7, v1
    v_lshlrev_b32 v8, 12, v8
L_gate_43:
    buffer_load_dword v72, v8, s[52:55], s13 offen sc1
    s_waitcnt vmcnt(0)
    v_cmp_eq_u32 vcc, -1, v72
    s_nop 0
    s_bcnt1_i32_b64 s12, vcc
    s_cmp_le_u32 s12, 56
    s_cbranch_scc1 L_gdone_42
    s_sub_u32 s75, s75, 1
    s_cbranch_scc1 L_exit
    s_sleep 8
    s_branch L_gate_43
L_gdone_42:
    v_add_u32 v69, 0x1000, v4
    v_add_u32 v70, 0x2000, v4
    v_add_u32 v71, 0x3000, v4
    s_mov_b64 s[78:79], -1
    s_mov_b64 s[80:81], -1
    s_mov_b64 s[82:83], -1
    s_mov_b64 s[84:85], -1
L_poll_45:
    s_mov_b64 exec, s[78:79]
    s_cbranch_execz L_psk_46
    buffer_load_dwordx2 v[72:73], v4, s[52:55], s13 offen offset:0 sc1
    buffer_load_dwordx2 v[74:75], v69, s[52:55], s13 offen offset:0 sc1
L_psk_46:
    s_mov_b64 exec, s[80:81]
    s_cbranch_execz L_psk_47
    buffer_load_dwordx2 v[76:77], v70, s[52:55], s13 offen offset:0 sc1
    buffer_load_dwordx2 v[78:79], v71, s[52:55], s13 offen offset:0 sc1
L_psk_47:
    s_mov_b64 exec, s[82:83]
    s_cbranch_execz L_psk_48
    buffer_load_dwordx2 v[80:81], v4, s[52:55], s11 offen offset:0 sc1
    buffer_load_dwordx2 v[82:83], v69, s[52:55], s11 offen offset:0 sc1
L_psk_48:
    s_mov_b64 exec, s[84:85]
    s_cbranch_execz L_psk_49
    buffer_load_dwordx2 v[84:85], v70, s[52:55], s11 offen offset:0 sc1
    buffer_load_dwordx2 v[86:87], v71, s[52:55], s11 offen offset:0 sc1
L_psk_49:
    s_mov_b64 exec, -1
    s_waitcnt vmcnt(0)
    v_max_u32 v8, v72, v73
    v_max3_u32 v8, v8, v74, v75
    v_cmp_eq_u32 s[78:79], -1, v8
    v_max_u32 v8, v76, v77
    v_max3_u32 v8, v8, v78, v79
    v_cmp_eq_u32 s[80:81], -1, v8
    v_max_u32 v8, v80, v81
    v_max3_u32 v8, v8, v82, v83
    v_cmp_eq_u32 s[82:83], -1, v8
    v_max_u32 v8, v84, v85
    v_max3_u32 v8, v8, v86, v87
    v_cmp_eq_u32 s[84:85], -1, v8
    s_nop 0
    s_mov_b64 vcc, s[78:79]
    s_or_b64 vcc, vcc, s[80:81]
    s_or_b64 vcc, vcc, s[82:83]
    s_or_b64 vcc, vcc, s[84:85]
    s_cmp_eq_u64 vcc, 0
    s_cbranch_scc1 L_pdone_44
    s_sub_u32 s75, s75, 1
    s_cbranch_scc1 L_exit
    s_branch L_poll_45
L_pdone_44:
    v_add_f32 v8, v72, v74
    v_add_f32 v9, v73, v75
    v_add_f32 v8, v8, v76
    v_add_f32 v9, v9, v77
    v_add_f32 v8, v8, v78
    v_add_f32 v9, v9, v79
    v_add_f32 v8, v8, v80
    v_add_f32 v9, v9, v81
    v_add_f32 v8, v8, v82
    v_add_f32 v9, v9, v83
    v_add_f32 v8, v8, v84
    v_add_f32 v9, v9, v85
    v_add_f32 v8, v8, v86
    v_add_f32 v9, v9, v87
    v_cvt_pk_bf16_f32 v8, 0, v8
    v_cvt_pk_bf16_f32 v9, 0, v9
    v_lshlrev_b32 v10, 16, v88
    v_and_b32 v11, 0xffff0000, v88
    v_add_f32 v8, v8, v10
    v_add_f32 v9, v9, v11
    v_cvt_pk_bf16_f32 v10, 0, v8
    v_cvt_pk_bf16_f32 v11, 0, v9
    v_cvt_pk_bf16_f32 v8, v8, v9
    v_readfirstlane_b32 s12, v10
    ds_write_b32 v7, v8 offset:1024
    v_lshrrev_b32 v4, 3, v3
    v_subrev_f32 v10, s12, v10
    v_subrev_f32 v11, s12, v11
    v_add_f32 v12, v10, v11
    v_mul_f32 v13, v10, v10
    v_fmac_f32 v13, v11, v11
    v_lshlrev_b32 v7, 5, v4
    v_add_f32_dpp v12, v12, v12 quad_perm:[1,0,3,2] row_mask:0xf bank_mask:0xf
    s_nop 0
    v_add_f32_dpp v13, v13, v13 quad_perm:[1,0,3,2] row_mask:0xf bank_mask:0xf
    s_nop 0
    v_add_f32_dpp v12, v12, v12 quad_perm:[2,3,0,1] row_mask:0xf bank_mask:0xf
    s_nop 0
    v_add_f32_dpp v13, v13, v13 quad_perm:[2,3,0,1] row_mask:0xf bank_mask:0xf
    s_nop 0
    v_add_f32_dpp v12, v12, v12 row_half_mirror row_mask:0xf bank_mask:0xf
    s_nop 0
    v_add_f32_dpp v13, v13, v13 row_half_mirror row_mask:0xf bank_mask:0xf
    s_nop 0
    v_add_f32_dpp v12, v12, v12 row_mirror row_mask:0xf bank_mask:0xf
    s_nop 0
    v_add_f32_dpp v13, v13, v13 row_mirror row_mask:0xf bank_mask:0xf
    v_mov_b32 v14, v12
    v_mov_b32 v15, v13
    s_nop 0
    v_permlane16_swap_b32 v12, v14
    v_permlane16_swap_b32 v13, v15
    v_add_f32 v12, v12, v14
    v_add_f32 v13, v13, v15
    v_mov_b32 v14, v12
    v_mov_b32 v15, v13
    s_nop 0
    v_permlane32_swap_b32 v12, v14
    v_permlane32_swap_b32 v13, v15
    v_add_f32 v12, v12, v14
    v_add_f32 v13, v13, v15
    v_lshlrev_b32 v4, 10, v4
    v_mul_f32 v14, 0x3c000000, v12
    v_lshl_add_u32 v4, v2, 5, v4
    v_fma_f32 v13, -v14, v12, v13
    v_add_f32 v12, s12, v14
    s_lshl_b32 s13, s3, 3
    v_mov_b32 v14, s13
    ds_write_b64 v14, v[12:13] offset:11520
    s_lshl_b32 s13, s3, 7
    v_add_u32 v4, s13, v4
    s_waitcnt lgkmcnt(0)
    s_barrier
    ds_read_b128 v[8:11], v7 offset:11520
    ds_read_b128 v[12:15], v7 offset:11536
    ds_read_b128 v[16:19], v4 offset:1024
    ds_read_b128 v[20:23], v4 offset:1040
    s_waitcnt lgkmcnt(2)
    v_add_f32 v50, v8, v10
    v_add_f32 v51, v12, v14
    v_add_f32 v9, v9, v11
    v_add_f32 v50, v50, v51
    v_add_f32 v13, v13, v15
    v_mul_f32 v50, 0x3e800000, v50
    v_add_f32 v9, v9, v13
    v_sub_f32 v8, v8, v50
    v_sub_f32 v10, v10, v50
    v_sub_f32 v12, v12, v50
    v_sub_f32 v14, v14, v50
    v_mul_f32 v51, v8, v8
    v_fmac_f32 v51, v10, v10
    v_fmac_f32 v51, v12, v12
    v_fmac_f32 v51, v14, v14
    v_mul_f32 v9, 0x3b000000, v9
    v_fmamk_f32 v51, v51, 0x3e800000, v9
    v_cvt_pk_bf16_f32 v50, 0, v50
    v_cvt_pk_bf16_f32 v51, 0, v51
    v_add_f32 v51, 0x3727c5ac, v51
    v_cvt_pk_bf16_f32 v51, 0, v51
    v_sqrt_f32 v51, v51
    s_nop 0
    v_cvt_pk_bf16_f32 v51, 0, v51
    v_rcp_f32 v51, v51
    s_waitcnt lgkmcnt(0)
    v_lshlrev_b32 v32, 16, v16
    v_and_b32 v33, 0xffff0000, v16
    v_pk_add_f32 v[32:33], v[32:33], v[50:51] op_sel_hi:[1,0] neg_lo:[0,1] neg_hi:[0,1]
    v_cvt_pk_bf16_f32 v32, 0, v32
    v_cvt_pk_bf16_f32 v33, 0, v33
    v_pk_mul_f32 v[32:33], v[32:33], v[50:51] op_sel:[0,1] op_sel_hi:[1,1]
    v_cvt_pk_bf16_f32 v16, v32, v33
    v_lshlrev_b32 v34, 16, v17
    v_and_b32 v35, 0xffff0000, v17
    v_pk_add_f32 v[34:35], v[34:35], v[50:51] op_sel_hi:[1,0] neg_lo:[0,1] neg_hi:[0,1]
    v_cvt_pk_bf16_f32 v34, 0, v34
    v_cvt_pk_bf16_f32 v35, 0, v35
    v_pk_mul_f32 v[34:35], v[34:35], v[50:51] op_sel:[0,1] op_sel_hi:[1,1]
    v_cvt_pk_bf16_f32 v17, v34, v35
    v_lshlrev_b32 v36, 16, v18
    v_and_b32 v37, 0xffff0000, v18
    v_pk_add_f32 v[36:37], v[36:37], v[50:51] op_sel_hi:[1,0] neg_lo:[0,1] neg_hi:[0,1]
    v_cvt_pk_bf16_f32 v36, 0, v36
    v_cvt_pk_bf16_f32 v37, 0, v37
    v_pk_mul_f32 v[36:37], v[36:37], v[50:51] op_sel:[0,1] op_sel_hi:[1,1]
    v_cvt_pk_bf16_f32 v18, v36, v37
    v_lshlrev_b32 v38, 16, v19
    v_and_b32 v39, 0xffff0000, v19
    v_pk_add_f32 v[38:39], v[38:39], v[50:51] op_sel_hi:[1,0] neg_lo:[0,1] neg_hi:[0,1]
    v_cvt_pk_bf16_f32 v38, 0, v38
    v_cvt_pk_bf16_f32 v39, 0, v39
    v_pk_mul_f32 v[38:39], v[38:39], v[50:51] op_sel:[0,1] op_sel_hi:[1,1]
    v_cvt_pk_bf16_f32 v19, v38, v39
    v_lshlrev_b32 v32, 16, v20
    v_and_b32 v33, 0xffff0000, v20
    v_pk_add_f32 v[32:33], v[32:33], v[50:51] op_sel_hi:[1,0] neg_lo:[0,1] neg_hi:[0,1]
    v_cvt_pk_bf16_f32 v32, 0, v32
    v_cvt_pk_bf16_f32 v33, 0, v33
    v_pk_mul_f32 v[32:33], v[32:33], v[50:51] op_sel:[0,1] op_sel_hi:[1,1]
    v_cvt_pk_bf16_f32 v20, v32, v33
    v_lshlrev_b32 v34, 16, v21
    v_and_b32 v35, 0xffff0000, v21
    v_pk_add_f32 v[34:35], v[34:35], v[50:51] op_sel_hi:[1,0] neg_lo:[0,1] neg_hi:[0,1]
    v_cvt_pk_bf16_f32 v34, 0, v34
    v_cvt_pk_bf16_f32 v35, 0, v35
    v_pk_mul_f32 v[34:35], v[34:35], v[50:51] op_sel:[0,1] op_sel_hi:[1,1]
    v_cvt_pk_bf16_f32 v21, v34, v35
    v_lshlrev_b32 v36, 16, v22
    v_and_b32 v37, 0xffff0000, v22
    v_pk_add_f32 v[36:37], v[36:37], v[50:51] op_sel_hi:[1,0] neg_lo:[0,1] neg_hi:[0,1]
    v_cvt_pk_bf16_f32 v36, 0, v36
    v_cvt_pk_bf16_f32 v37, 0, v37
    v_pk_mul_f32 v[36:37], v[36:37], v[50:51] op_sel:[0,1] op_sel_hi:[1,1]
    v_cvt_pk_bf16_f32 v22, v36, v37
    v_lshlrev_b32 v38, 16, v23
    v_and_b32 v39, 0xffff0000, v23
    v_pk_add_f32 v[38:39], v[38:39], v[50:51] op_sel_hi:[1,0] neg_lo:[0,1] neg_hi:[0,1]
    v_cvt_pk_bf16_f32 v38, 0, v38
    v_cvt_pk_bf16_f32 v39, 0, v39
    v_pk_mul_f32 v[38:39], v[38:39], v[50:51] op_sel:[0,1] op_sel_hi:[1,1]
    v_cvt_pk_bf16_f32 v23, v38, v39
    v_perm_b32 v52, v16, v16, v232
    v_perm_b32 v53, v16, v16, v233
    v_perm_b32 v54, v16, v16, v234
    v_perm_b32 v55, v16, v16, v235
    v_perm_b32 v56, v16, v16, v236
    v_perm_b32 v57, v16, v16, v237
    v_perm_b32 v58, v16, v16, v238
    v_perm_b32 v59, v16, v16, v239
    v_mfma_f32_16x16x32_bf16 v[60:63], v[52:55], v[136:139], 0
    v_perm_b32 v52, v17, v17, v232
    v_perm_b32 v53, v17, v17, v233
    v_perm_b32 v54, v17, v17, v234
    v_perm_b32 v55, v17, v17, v235
    v_mfma_f32_16x16x32_bf16 v[60:63], v[56:59], v[140:143], v[60:63]
    v_perm_b32 v56, v17, v17, v236
    v_perm_b32 v57, v17, v17, v237
    v_perm_b32 v58, v17, v17, v238
    v_perm_b32 v59, v17, v17, v239
    v_mfma_f32_16x16x32_bf16 v[60:63], v[52:55], v[144:147], v[60:63]
    v_perm_b32 v52, v18, v18, v232
    v_perm_b32 v53, v18, v18, v233
    v_perm_b32 v54, v18, v18, v234
    v_perm_b32 v55, v18, v18, v235
    v_mfma_f32_16x16x32_bf16 v[60:63], v[56:59], v[148:151], v[60:63]
    v_perm_b32 v56, v18, v18, v236
    v_perm_b32 v57, v18, v18, v237
    v_perm_b32 v58, v18, v18, v238
    v_perm_b32 v59, v18, v18, v239
    v_mfma_f32_16x16x32_bf16 v[60:63], v[52:55], v[152:155], v[60:63]
    v_perm_b32 v52, v19, v19, v232
    v_perm_b32 v53, v19, v19, v233
    v_perm_b32 v54, v19, v19, v234
    v_perm_b32 v55, v19, v19, v235
    v_mfma_f32_16x16x32_bf16 v[60:63], v[56:59], v[156:159], v[60:63]
    v_perm_b32 v56, v19, v19, v236
    v_perm_b32 v57, v19, v19, v237
    v_perm_b32 v58, v19, v19, v238
    v_perm_b32 v59, v19, v19, v239
    v_mfma_f32_16x16x32_bf16 v[60:63], v[52:55], v[160:163], v[60:63]
    v_perm_b32 v52, v20, v20, v232
    v_perm_b32 v53, v20, v20, v233
    v_perm_b32 v54, v20, v20, v234
    v_perm_b32 v55, v20, v20, v235
    v_mfma_f32_16x16x32_bf16 v[60:63], v[56:59], v[164:167], v[60:63]
    v_perm_b32 v56, v20, v20, v236
    v_perm_b32 v57, v20, v20, v237
    v_perm_b32 v58, v20, v20, v238
    v_perm_b32 v59, v20, v20, v239
    v_mfma_f32_16x16x32_bf16 v[60:63], v[52:55], v[168:171], v[60:63]
    v_perm_b32 v52, v21, v21, v232
    v_perm_b32 v53, v21, v21, v233
    v_perm_b32 v54, v21, v21, v234
    v_perm_b32 v55, v21, v21, v235
    v_mfma_f32_16x16x32_bf16 v[60:63], v[56:59], v[172:175], v[60:63]
    v_perm_b32 v56, v21, v21, v236
    v_perm_b32 v57, v21, v21, v237
    v_perm_b32 v58, v21, v21, v238
    v_perm_b32 v59, v21, v21, v239
    v_mfma_f32_16x16x32_bf16 v[60:63], v[52:55], v[176:179], v[60:63]
    v_perm_b32 v52, v22, v22, v232
    v_perm_b32 v53, v22, v22, v233
    v_perm_b32 v54, v22, v22, v234
    v_perm_b32 v55, v22, v22, v235
    v_mfma_f32_16x16x32_bf16 v[60:63], v[56:59], v[180:183], v[60:63]
    v_perm_b32 v56, v22, v22, v236
    v_perm_b32 v57, v22, v22, v237
    v_perm_b32 v58, v22, v22, v238
    v_perm_b32 v59, v22, v22, v239
    v_mfma_f32_16x16x32_bf16 v[60:63], v[52:55], v[184:187], v[60:63]
    v_perm_b32 v52, v23, v23, v232
    v_perm_b32 v53, v23, v23, v233
    v_perm_b32 v54, v23, v23, v234
    v_perm_b32 v55, v23, v23, v235
    v_mfma_f32_16x16x32_bf16 v[60:63], v[56:59], v[188:191], v[60:63]
    v_perm_b32 v56, v23, v23, v236
    v_perm_b32 v57, v23, v23, v237
    v_perm_b32 v58, v23, v23, v238
    v_perm_b32 v59, v23, v23, v239
    v_mfma_f32_16x16x32_bf16 v[60:63], v[52:55], v[192:195], v[60:63]
    s_nop 1
    v_mfma_f32_16x16x32_bf16 v[60:63], v[56:59], v[196:199], v[60:63]
    v_lshlrev_b32 v4, 4, v0
    s_nop 7
    ds_write_b128 v4, v[60:63] offset:3072
    v_lshrrev_b32 v4, 5, v1
    v_lshlrev_b32 v4, 9, v4
    v_bfe_u32 v7, v1, 2, 1
    v_lshl_add_u32 v4, v7, 8, v4
    v_bfe_u32 v7, v1, 3, 2
    v_lshl_add_u32 v4, v7, 4, v4
    v_and_b32 v7, 3, v1
    v_lshl_add_u32 v4, v7, 2, v4
    s_waitcnt lgkmcnt(0)
    s_barrier
    s_cmp_lt_u32 s3, 4
    s_cbranch_scc1 L_done
    ds_read_b32 v8, v4 offset:3072
    ds_read_b32 v16, v4 offset:3136
    ds_read_b32 v9, v4 offset:4096
    ds_read_b32 v17, v4 offset:4160
    ds_read_b32 v10, v4 offset:5120
    ds_read_b32 v18, v4 offset:5184
    ds_read_b32 v11, v4 offset:6144
    ds_read_b32 v19, v4 offset:6208
    ds_read_b32 v12, v4 offset:7168
    ds_read_b32 v20, v4 offset:7232
    ds_read_b32 v13, v4 offset:8192
    ds_read_b32 v21, v4 offset:8256
    ds_read_b32 v14, v4 offset:9216
    ds_read_b32 v22, v4 offset:9280
    ds_read_b32 v15, v4 offset:10240
    ds_read_b32 v23, v4 offset:10304
    s_lshl_b32 s12, s3, 7
    v_lshl_add_u32 v4, v1, 1, s12
    v_lshrrev_b32 v31, 3, v3
    v_lshlrev_b32 v31, 6, v31
    v_lshl_add_u32 v31, v2, 4, v31
    v_add_u32 v31, s12, v31
    s_waitcnt lgkmcnt(12)
    v_add_f32 v8, v8, v9
    v_add_f32 v16, v16, v17
    s_waitcnt lgkmcnt(10)
    v_add_f32 v8, v8, v10
    v_add_f32 v16, v16, v18
    s_waitcnt lgkmcnt(8)
    v_add_f32 v8, v8, v11
    v_add_f32 v16, v16, v19
    s_waitcnt lgkmcnt(6)
    v_add_f32 v8, v8, v12
    v_add_f32 v16, v16, v20
    s_waitcnt lgkmcnt(4)
    v_add_f32 v8, v8, v13
    v_add_f32 v16, v16, v21
    s_waitcnt lgkmcnt(2)
    v_add_f32 v8, v8, v14
    v_add_f32 v16, v16, v22
    s_waitcnt lgkmcnt(0)
    v_add_f32 v8, v8, v15
    v_add_f32 v16, v16, v23
    v_cvt_pk_bf16_f32 v8, 0, v8
    v_cvt_pk_bf16_f32 v16, 0, v16
    v_mul_f32 v9, 0xbfb8aa3b, v8
    v_exp_f32 v9, v9
    s_nop 0
    v_add_f32 v9, 1.0, v9
    v_rcp_f32 v10, v9
    s_nop 0
    v_mul_f32 v11, v8, v10
    v_fma_f32 v12, -v11, v9, v8
    v_fmac_f32 v11, v12, v10
    v_cvt_pk_bf16_f32 v11, 0, v11
    v_mul_f32 v11, v11, v16
    v_cvt_pk_bf16_f32 v11, v11, v11
    ds_write_b16 v4, v11 offset:512
    v_lshrrev_b32 v4, 1, v2
    v_lshlrev_b32 v4, 11, v4
    v_lshl_add_u32 v4, v3, 5, v4
    v_and_b32 v7, 1, v2
    v_lshl_add_u32 v4, v7, 4, v4
    s_lshl_b32 s13, s76, 12
    s_and_b32 s12, s3, 3
    s_lshl_b32 s12, s12, 9
    s_add_u32 s13, s13, s12
    s_add_u32 s13, s13, 0x20000
    s_waitcnt lgkmcnt(0)
    ds_read_b128 v[16:19], v31 offset:512
    s_waitcnt lgkmcnt(0)
    v_perm_b32 v52, v16, v16, v232
    v_perm_b32 v53, v16, v16, v233
    v_perm_b32 v54, v16, v16, v234
    v_perm_b32 v55, v16, v16, v235
    v_perm_b32 v56, v16, v16, v236
    v_perm_b32 v57, v16, v16, v237
    v_perm_b32 v58, v16, v16, v238
    v_perm_b32 v59, v16, v16, v239
    v_mfma_f32_16x16x32_bf16 v[60:63], v[52:55], v[200:203], 0
    v_perm_b32 v52, v17, v17, v232
    v_perm_b32 v53, v17, v17, v233
    v_perm_b32 v54, v17, v17, v234
    v_perm_b32 v55, v17, v17, v235
    v_mfma_f32_16x16x32_bf16 v[60:63], v[56:59], v[204:207], v[60:63]
    v_perm_b32 v56, v17, v17, v236
    v_perm_b32 v57, v17, v17, v237
    v_perm_b32 v58, v17, v17, v238
    v_perm_b32 v59, v17, v17, v239
    v_mfma_f32_16x16x32_bf16 v[60:63], v[52:55], v[208:211], v[60:63]
    v_perm_b32 v52, v18, v18, v232
    v_perm_b32 v53, v18, v18, v233
    v_perm_b32 v54, v18, v18, v234
    v_perm_b32 v55, v18, v18, v235
    v_mfma_f32_16x16x32_bf16 v[60:63], v[56:59], v[212:215], v[60:63]
    v_perm_b32 v56, v18, v18, v236
    v_perm_b32 v57, v18, v18, v237
    v_perm_b32 v58, v18, v18, v238
    v_perm_b32 v59, v18, v18, v239
    v_mfma_f32_16x16x32_bf16 v[60:63], v[52:55], v[216:219], v[60:63]
    v_perm_b32 v52, v19, v19, v232
    v_perm_b32 v53, v19, v19, v233
    v_perm_b32 v54, v19, v19, v234
    v_perm_b32 v55, v19, v19, v235
    v_mfma_f32_16x16x32_bf16 v[60:63], v[56:59], v[220:223], v[60:63]
    v_perm_b32 v56, v19, v19, v236
    v_perm_b32 v57, v19, v19, v237
    v_perm_b32 v58, v19, v19, v238
    v_perm_b32 v59, v19, v19, v239
    v_mfma_f32_16x16x32_bf16 v[60:63], v[52:55], v[224:227], v[60:63]
    s_nop 1
    v_mfma_f32_16x16x32_bf16 v[60:63], v[56:59], v[228:231], v[60:63]
    s_nop 7
    v_min_u32 v60, -2, v60
    v_min_u32 v61, -2, v61
    v_min_u32 v62, -2, v62
    v_min_u32 v63, -2, v63
    buffer_store_dwordx4 v[60:63], v4, s[52:55], s13 offen offset:0 sc1
    s_branch L_done
L_fin:
    s_cmp_ge_u32 s3, 1
    s_cbranch_scc1 L_done
    v_and_b32 v7, 7, v1
    v_lshlrev_b32 v4, 4, v7
    v_add_u32 v69, 0x1000, v4
    v_add_u32 v70, 0x2000, v4
    v_add_u32 v71, 0x3000, v4
    v_lshlrev_b32 v7, 3, v7
    s_lshl_b32 s12, s2, 6
    buffer_load_dwordx2 v[132:133], v7, s[64:67], s12 offen
L_nx_50:
    s_lshl_b32 s12, s2, 7
    s_add_u32 s13, s12, 0xc000
    s_add_u32 s11, s12, 0x10000
    s_mov_b64 s[78:79], -1
    s_mov_b64 s[80:81], -1
    s_mov_b64 s[82:83], -1
    s_mov_b64 s[84:85], -1
L_poll_52:
    s_mov_b64 exec, s[78:79]
    s_cbranch_execz L_psk_53
    buffer_load_dwordx4 v[72:75], v4, s[52:55], s13 offen offset:0 sc1
    buffer_load_dwordx4 v[76:79], v69, s[52:55], s13 offen offset:0 sc1
L_psk_53:
    s_mov_b64 exec, s[80:81]
    s_cbranch_execz L_psk_54
    buffer_load_dwordx4 v[80:83], v70, s[52:55], s13 offen offset:0 sc1
    buffer_load_dwordx4 v[84:87], v71, s[52:55], s13 offen offset:0 sc1
L_psk_54:
    s_mov_b64 exec, s[82:83]
    s_cbranch_execz L_psk_55
    buffer_load_dwordx4 v[88:91], v4, s[52:55], s11 offen offset:0 sc1
    buffer_load_dwordx4 v[92:95], v69, s[52:55], s11 offen offset:0 sc1
L_psk_55:
    s_mov_b64 exec, s[84:85]
    s_cbranch_execz L_psk_56
    buffer_load_dwordx4 v[96:99], v70, s[52:55], s11 offen offset:0 sc1
    buffer_load_dwordx4 v[100:103], v71, s[52:55], s11 offen offset:0 sc1
L_psk_56:
    s_mov_b64 exec, -1
    s_waitcnt vmcnt(0)
    v_max_u32 v8, v72, v73
    v_max3_u32 v8, v8, v74, v75
    v_max3_u32 v8, v8, v76, v77
    v_max3_u32 v8, v8, v78, v79
    v_cmp_eq_u32 s[78:79], -1, v8
    v_max_u32 v8, v80, v81
    v_max3_u32 v8, v8, v82, v83
    v_max3_u32 v8, v8, v84, v85
    v_max3_u32 v8, v8, v86, v87
    v_cmp_eq_u32 s[80:81], -1, v8
    v_max_u32 v8, v88, v89
    v_max3_u32 v8, v8, v90, v91
    v_max3_u32 v8, v8, v92, v93
    v_max3_u32 v8, v8, v94, v95
    v_cmp_eq_u32 s[82:83], -1, v8
    v_max_u32 v8, v96, v97
    v_max3_u32 v8, v8, v98, v99
    v_max3_u32 v8, v8, v100, v101
    v_max3_u32 v8, v8, v102, v103
    v_cmp_eq_u32 s[84:85], -1, v8
    s_nop 0
    s_mov_b64 vcc, s[78:79]
    s_or_b64 vcc, vcc, s[80:81]
    s_or_b64 vcc, vcc, s[82:83]
    s_or_b64 vcc, vcc, s[84:85]
    s_cmp_eq_u64 vcc, 0
    s_cbranch_scc1 L_pdone_51
    s_sub_u32 s75, s75, 1
    s_cbranch_scc1 L_exit
    s_sleep 8
    s_branch L_poll_52
L_pdone_51:
    v_add_f32 v8, v72, v76
    v_add_f32 v9, v73, v77
    v_add_f32 v10, v74, v78
    v_add_f32 v11, v75, v79
    v_add_f32 v8, v8, v80
    v_add_f32 v9, v9, v81
    v_add_f32 v10, v10, v82
    v_add_f32 v11, v11, v83
    v_add_f32 v8, v8, v84
    v_add_f32 v9, v9, v85
    v_add_f32 v10, v10, v86
    v_add_f32 v11, v11, v87
    v_add_f32 v8, v8, v88
    v_add_f32 v9, v9, v89
    v_add_f32 v10, v10, v90
    v_add_f32 v11, v11, v91
    v_add_f32 v8, v8, v92
    v_add_f32 v9, v9, v93
    v_add_f32 v10, v10, v94
    v_add_f32 v11, v11, v95
    v_add_f32 v8, v8, v96
    v_add_f32 v9, v9, v97
    v_add_f32 v10, v10, v98
    v_add_f32 v11, v11, v99
    v_add_f32 v8, v8, v100
    v_add_f32 v9, v9, v101
    v_add_f32 v10, v10, v102
    v_add_f32 v11, v11, v103
    v_cvt_pk_bf16_f32 v8, 0, v8
    v_cvt_pk_bf16_f32 v9, 0, v9
    v_cvt_pk_bf16_f32 v10, 0, v10
    v_cvt_pk_bf16_f32 v11, 0, v11
    v_lshlrev_b32 v12, 16, v132
    v_and_b32 v13, 0xffff0000, v132
    v_lshlrev_b32 v14, 16, v133
    v_and_b32 v15, 0xffff0000, v133
    v_add_f32 v8, v8, v12
    v_add_f32 v9, v9, v13
    v_add_f32 v10, v10, v14
    v_add_f32 v11, v11, v15
    v_cvt_pk_bf16_f32 v8, 0, v8
    v_cvt_pk_bf16_f32 v9, 0, v9
    v_cvt_pk_bf16_f32 v10, 0, v10
    v_cvt_pk_bf16_f32 v11, 0, v11
    v_lshrrev_b32 v16, 3, v1
    v_lshl_add_u32 v4, v16, 12, v4
    v_add_u32 v69, 0x8000, v4
    v_add_u32 v70, 0x10000, v4
    v_add_u32 v71, 0x18000, v4
    s_lshl_b32 s12, s2, 7
    s_add_u32 s13, s12, 0x20000
    s_add_u32 s11, s13, 0x20000
    s_mov_b64 s[78:79], -1
    s_mov_b64 s[80:81], -1
    s_mov_b64 s[82:83], -1
    s_mov_b64 s[84:85], -1
L_poll_58:
    s_mov_b64 exec, s[78:79]
    s_cbranch_execz L_psk_59
    buffer_load_dwordx4 v[72:75], v4, s[52:55], s13 offen offset:0 sc1
    buffer_load_dwordx4 v[76:79], v69, s[52:55], s13 offen offset:0 sc1
L_psk_59:
    s_mov_b64 exec, s[80:81]
    s_cbranch_execz L_psk_60
    buffer_load_dwordx4 v[80:83], v70, s[52:55], s13 offen offset:0 sc1
    buffer_load_dwordx4 v[84:87], v71, s[52:55], s13 offen offset:0 sc1
L_psk_60:
    s_mov_b64 exec, s[82:83]
    s_cbranch_execz L_psk_61
    buffer_load_dwordx4 v[88:91], v4, s[52:55], s11 offen offset:0 sc1
    buffer_load_dwordx4 v[92:95], v69, s[52:55], s11 offen offset:0 sc1
L_psk_61:
    s_mov_b64 exec, s[84:85]
    s_cbranch_execz L_psk_62
    buffer_load_dwordx4 v[96:99], v70, s[52:55], s11 offen offset:0 sc1
L_psk_62:
    s_mov_b64 exec, -1
    s_waitcnt vmcnt(0)
    v_max_u32 v16, v72, v73
    v_max3_u32 v16, v16, v74, v75
    v_max3_u32 v16, v16, v76, v77
    v_max3_u32 v16, v16, v78, v79
    v_cmp_eq_u32 s[78:79], -1, v16
    v_max_u32 v16, v80, v81
    v_max3_u32 v16, v16, v82, v83
    v_max3_u32 v16, v16, v84, v85
    v_max3_u32 v16, v16, v86, v87
    v_cmp_eq_u32 s[80:81], -1, v16
    v_max_u32 v16, v88, v89
    v_max3_u32 v16, v16, v90, v91
    v_max3_u32 v16, v16, v92, v93
    v_max3_u32 v16, v16, v94, v95
    v_cmp_eq_u32 s[82:83], -1, v16
    v_max_u32 v16, v96, v97
    v_max3_u32 v16, v16, v98, v99
    v_cmp_eq_u32 s[84:85], -1, v16
    s_nop 0
    s_mov_b64 vcc, s[78:79]
    s_or_b64 vcc, vcc, s[80:81]
    s_or_b64 vcc, vcc, s[82:83]
    s_or_b64 vcc, vcc, s[84:85]
    s_cmp_eq_u64 vcc, 0
    s_cbranch_scc1 L_pdone_57
    s_sub_u32 s75, s75, 1
    s_cbranch_scc1 L_exit
    s_branch L_poll_58
L_pdone_57:
    v_add_f32 v12, v72, v76
    v_add_f32 v13, v73, v77
    v_add_f32 v14, v74, v78
    v_add_f32 v15, v75, v79
    v_add_f32 v12, v12, v80
    v_add_f32 v13, v13, v81
    v_add_f32 v14, v14, v82
    v_add_f32 v15, v15, v83
    v_add_f32 v12, v12, v84
    v_add_f32 v13, v13, v85
    v_add_f32 v14, v14, v86
    v_add_f32 v15, v15, v87
    v_add_f32 v12, v12, v88
    v_add_f32 v13, v13, v89
    v_add_f32 v14, v14, v90
    v_add_f32 v15, v15, v91
    v_add_f32 v12, v12, v92
    v_add_f32 v13, v13, v93
    v_add_f32 v14, v14, v94
    v_add_f32 v15, v15, v95
    v_add_f32 v12, v12, v96
    v_add_f32 v13, v13, v97
    v_add_f32 v14, v14, v98
    v_add_f32 v15, v15, v99
    s_nop 1
    v_add_f32_dpp v12, v12, v12 row_ror:8 row_mask:0xf bank_mask:0xf
    v_add_f32_dpp v13, v13, v13 row_ror:8 row_mask:0xf bank_mask:0xf
    v_add_f32_dpp v14, v14, v14 row_ror:8 row_mask:0xf bank_mask:0xf
    v_add_f32_dpp v15, v15, v15 row_ror:8 row_mask:0xf bank_mask:0xf
    v_mov_b32 v16, v12
    v_mov_b32 v17, v13
    v_mov_b32 v18, v14
    v_mov_b32 v19, v15
    s_nop 0
    v_permlane16_swap_b32 v12, v16
    v_permlane16_swap_b32 v13, v17
    v_permlane16_swap_b32 v14, v18
    v_permlane16_swap_b32 v15, v19
    v_add_f32 v12, v12, v16
    v_add_f32 v13, v13, v17
    v_add_f32 v14, v14, v18
    v_add_f32 v15, v15, v19
    v_mov_b32 v16, v12
    v_mov_b32 v17, v13
    v_mov_b32 v18, v14
    v_mov_b32 v19, v15
    s_nop 0
    v_permlane32_swap_b32 v12, v16
    v_permlane32_swap_b32 v13, v17
    v_permlane32_swap_b32 v14, v18
    v_permlane32_swap_b32 v15, v19
    v_add_f32 v12, v12, v16
    v_add_f32 v13, v13, v17
    v_add_f32 v14, v14, v18
    v_add_f32 v15, v15, v19
    v_cvt_pk_bf16_f32 v12, 0, v12
    v_cvt_pk_bf16_f32 v13, 0, v13
    v_cvt_pk_bf16_f32 v14, 0, v14
    v_cvt_pk_bf16_f32 v15, 0, v15
    v_add_f32 v8, v8, v12
    v_add_f32 v9, v9, v13
    v_add_f32 v10, v10, v14
    v_add_f32 v11, v11, v15
    v_cvt_pk_bf16_f32 v8, v8, v9
    v_cvt_pk_bf16_f32 v9, v10, v11
    s_lshl_b32 s12, s2, 6
    s_mov_b64 exec, 0xff
    buffer_store_dwordx2 v[8:9], v7, s[68:71], s12 offen offset:0
    s_cmp_lg_u32 s2, 0
    s_cbranch_scc1 L_noep
    v_mov_b32 v8, s72
    v_mov_b32 v4, 0
    s_mov_b64 exec, 1
    buffer_store_dword v8, v4, s[52:55], 0 offen offset:0
L_noep:
    s_mov_b64 exec, -1
L_done:
L_exit:
    s_endpgm
.section .rodata,"a"
.p2align 6
.amdhsa_kernel sequential_preLN__gqa_block_cached__swiglu_ffn__decode_kernel
  .amdhsa_next_free_vgpr 248
  .amdhsa_next_free_sgpr 102
  .amdhsa_accum_offset 248
  .amdhsa_group_segment_fixed_size 0
  .amdhsa_kernarg_size 96
  .amdhsa_user_sgpr_count 2
  .amdhsa_user_sgpr_kernarg_segment_ptr 1
  .amdhsa_system_sgpr_workgroup_id_x 1
.end_amdhsa_kernel
```
